```python
import torch

def _softmax(x, axis=-1):
    return torch.softmax(x, dim=axis)
def _gelu(x):
    return torch.nn.functional.gelu(x, approximate="tanh")
def _silu(x):
    return torch.nn.functional.silu(x)
def _sigmoid(x):
    return torch.sigmoid(x)
def _layernorm(x, axis=-1, eps=1e-5):
    m = x.mean(dim=axis, keepdim=True)
    v = x.var(dim=axis, keepdim=True, unbiased=False)
    return (x - m) / torch.sqrt(v + eps)
def _scatter_add(tgt, idx, src, axis=0):
    return tgt.clone().index_add_(axis, idx, src)
def _segment_sum(src, seg, n):
    out = torch.zeros((n,) + src.shape[1:], dtype=src.dtype)
    return out.index_add_(0, seg, src)
def _pad(x, pw):
    flat = tuple(v for pair in reversed(pw) for v in pair)
    return torch.nn.functional.pad(x, flat)

kernel_name = 'sequential_preLN__ssm_conv_s4__mixer_channel_mlp__prompt'

def setup_inputs():

    _w = (lambda a: (lambda t: t.to(torch.bfloat16) if t.is_floating_point() else t)(torch.as_tensor(a)))
    def _A_setup():
        B, L, D, N = 1, 2048, 512, 128
        A_re = -(lambda _x: torch.exp(torch.as_tensor(_x)))((lambda *s: torch.randn(*s, dtype=torch.bfloat16) * 3.2)(D, N))
        A_im = torch.pi * (lambda *s: torch.randn(*s, dtype=torch.bfloat16) * 0.05)(D, N)
        B_re = (lambda *s: torch.randn(*s, dtype=torch.bfloat16) * 0.1)(D, N)
        B_im = (lambda *s: torch.randn(*s, dtype=torch.bfloat16) * 0.1)(D, N)
        C_re = (lambda *s: torch.randn(*s, dtype=torch.bfloat16) * 0.1)(D, N)
        C_im = (lambda *s: torch.randn(*s, dtype=torch.bfloat16) * 0.1)(D, N)
        log_dt = (lambda *s: torch.randn(*s, dtype=torch.bfloat16) * 0.05)(D) * 0.5 - 4.0
        Dskip = (lambda *s: torch.randn(*s, dtype=torch.bfloat16) * 0.05)(D)
        return {
            "u": _w((lambda *s: torch.randn(*s, dtype=torch.bfloat16) * 0.05)(B, L, D)),
            "A_re": _w(A_re),
            "A_im": _w(A_im),
            "B_re": _w(B_re),
            "B_im": _w(B_im),
            "C_re": _w(C_re),
            "C_im": _w(C_im),
            "log_dt": _w(log_dt),
            "Dskip": _w(Dskip),
        }
    _A_in = _A_setup()

    def _B_setup():
        B, S, D, F = 1, 2048, 512, 1792
        return {
            "x": _w((lambda *s: torch.randn(*s, dtype=torch.bfloat16) * 0.05)(B, S, D)),
            "w1": _w((lambda *s: torch.randn(*s, dtype=torch.bfloat16) * 1.6)(D, F) * (D ** -0.5)),
            "b1": _w((lambda *s: torch.randn(*s, dtype=torch.bfloat16) * 0.8)(F)),
            "w2": _w((lambda *s: torch.randn(*s, dtype=torch.bfloat16) * 0.05)(F, D) * (F ** -0.5)),
            "b2": _w((lambda *s: torch.randn(*s, dtype=torch.bfloat16) * 0.05)(D)),
        }
    _B_in = _B_setup()

    return {
        "A_u": _A_in["u"],
        "A_A_re": _A_in["A_re"],
        "A_A_im": _A_in["A_im"],
        "A_B_re": _A_in["B_re"],
        "A_B_im": _A_in["B_im"],
        "A_C_re": _A_in["C_re"],
        "A_C_im": _A_in["C_im"],
        "A_log_dt": _A_in["log_dt"],
        "A_Dskip": _A_in["Dskip"],
        "B_x": _B_in["x"],
        "B_w1": _B_in["w1"],
        "B_b1": _B_in["b1"],
        "B_w2": _B_in["w2"],
        "B_b2": _B_in["b2"],
    }

def reference(A_u, A_A_re, A_A_im, A_B_re, A_B_im, A_C_re, A_C_im, A_log_dt, A_Dskip, B_x, B_w1, B_b1, B_w2, B_b2):
    def _A_ref(u, A_re, A_im, B_re, B_im, C_re, C_im, log_dt, Dskip):
        Bsz, L, D = u.shape
        dt = torch.exp(log_dt)[:, None]
        A = A_re + 1j * A_im
        Bc = B_re + 1j * B_im
        Cc = C_re + 1j * C_im
        logdA = dt * A
        dB = dt * Bc
        l = (lambda x, dt: x.to(dt))(torch.arange(L), A_re.dtype)
        P = torch.exp(logdA[:, :, None] * l[None, None, :])
        K = torch.einsum("dn,dnl,dn->dl", Cc, P, dB).real
        L2 = 2 * L
        Kp = _pad(K, ((0, 0), (0, L)))
        up = (lambda x, *d: x.permute(*d))(u, 0, 2, 1)
        up = _pad(up, ((0, 0), (0, 0), (0, L)))
        Kf = (lambda x, axes=(-2,-1): torch.fft.rfft2(x.float(), dim=axes))(Kp[:, None, :], axes=(-2, -1))
        Uf = (lambda x, axes=(-2,-1): torch.fft.rfft2(x.float(), dim=axes))(up[:, :, None, :], axes=(-2, -1))
        Yf = Uf * Kf[None, :, :, :]
        y = (lambda x, s, axes=(-2,-1): torch.fft.irfft2(x, s=s, dim=axes).to(torch.bfloat16))(Yf, (1, L2), axes=(-2, -1))[:, :, 0, :L]
        y = (lambda x, *d: x.permute(*d))(y, 0, 2, 1) + u * Dskip[None, None, :]
        return y

    def _B_ref(x, w1, b1, w2, b2):
        y = _layernorm(x, axis=-1)
        h = _gelu(torch.einsum("bsd,df->bsf", y, w1) + b1)
        return torch.einsum("bsf,fd->bsd", h, w2) + b2

    x = A_u
    h = x + _A_ref(_layernorm(x, axis=-1), A_A_re, A_A_im, A_B_re, A_B_im, A_C_re, A_C_im, A_log_dt, A_Dskip)
    h2 = h + _B_ref(_layernorm(h, axis=-1), B_w1, B_b1, B_w2, B_b2)
    return h2
```

```asm
; @launch grid=(256,1,1) block=(256,1,1) lds=163840
.amdgcn_target "amdgcn-amd-amdhsa--gfx950"
.text
.globl sequential_preLN__ssm_conv_s4__mixer_channel_mlp__prompt_kernel
.p2align 8
.type sequential_preLN__ssm_conv_s4__mixer_channel_mlp__prompt_kernel,@function
sequential_preLN__ssm_conv_s4__mixer_channel_mlp__prompt_kernel:
    s_cmp_ge_u32 s2, 256
    s_cbranch_scc1 sequential_preLN__ssm_conv_s4__mixer_channel_mlp__prompt_kernel_end
    s_load_dwordx16 s[4:19], s[0:1], 0
    s_load_dwordx2 s[20:21], s[0:1], 128
    s_load_dwordx2 s[24:25], s[0:1], 64
    s_load_dwordx4 s[28:31], s[0:1], 80
    s_load_dwordx4 s[32:35], s[0:1], 96
    s_load_dwordx2 s[36:37], s[0:1], 112
    v_lshrrev_b32 v1, 6, v0
    v_and_b32 v2, 63, v0
    v_and_b32 v3, 15, v2
    v_lshrrev_b32 v4, 4, v2
    v_readfirstlane_b32 s22, v1
    s_and_b32 s23, s2, 7
    s_lshr_b32 s26, s2, 3
    s_lshl_b32 s27, s23, 5
    s_add_u32 s27, s27, s26
    s_lshl_b32 s40, s2, 3
    s_lshl_b32 s41, s22, 1
    s_add_u32 s40, s40, s41
    s_lshl_b32 s41, s40, 10
    v_lshlrev_b32 v5, 4, v2
    v_add_u32 v6, s41, v5
    s_lshl_b32 s42, s26, 6
    s_lshl_b32 s43, s22, 4
    s_add_u32 s42, s42, s43
    v_lshrrev_b32 v8, 3, v2
    v_add_u32 v8, s42, v8
    v_lshlrev_b32 v8, 10, v8
    v_and_b32 v7, 7, v2
    v_lshlrev_b32 v7, 4, v7
    s_lshl_b32 s42, s23, 7
    v_add3_u32 v24, v8, v7, s42
    v_add_u32 v25, 8192, v24
    s_lshl_b32 s43, s22, 11
    s_add_u32 s43, s43, 114688
    s_lshr_b32 s42, s22, 1
    s_lshl_b32 s44, s27, 1
    s_add_u32 s44, s44, s42
    s_and_b32 s45, s22, 1
    s_lshl_b32 s45, s45, 6
    s_lshl_b32 s46, s44, 7
    s_add_u32 s46, s46, s45
    v_add_u32 v26, s46, v2
    v_lshlrev_b32 v26, 1, v26
    s_lshl_b32 s46, s44, 1
    v_mov_b32 v27, s46
    s_mov_b32 m0, s43
    s_waitcnt lgkmcnt(0)
    global_load_dwordx4 v[8:11], v6, s[4:5]
    global_load_dwordx4 v[12:15], v6, s[4:5] offset:1024
    global_load_lds_dwordx4 v24, s[4:5]
    s_add_u32 m0, s43, 1024
    s_load_dword s38, s[20:21], 0
    global_load_lds_dwordx4 v25, s[4:5]
    global_load_ushort v16, v26, s[6:7]
    global_load_ushort v17, v26, s[8:9]
    global_load_ushort v18, v26, s[10:11]
    global_load_ushort v19, v26, s[12:13]
    global_load_ushort v20, v26, s[14:15]
    global_load_ushort v21, v26, s[16:17]
    global_load_ushort v22, v27, s[18:19]
    global_load_ushort v23, v27, s[24:25]
    s_getpc_b64 s[62:63]
sequential_preLN__ssm_conv_s4__mixer_channel_mlp__prompt_kernel_pc:
    s_add_u32 s62, s62, (sequential_preLN__ssm_conv_s4__mixer_channel_mlp__prompt_kernel_tbl - sequential_preLN__ssm_conv_s4__mixer_channel_mlp__prompt_kernel_pc)
    s_addc_u32 s63, s63, 0
    v_lshlrev_b32 v6, 6, v0
    global_load_dwordx4 v[216:219], v6, s[62:63]
    global_load_dwordx4 v[220:223], v6, s[62:63] offset:16
    global_load_dwordx4 v[224:227], v6, s[62:63] offset:32
    global_load_dwordx4 v[228:231], v6, s[62:63] offset:48
    s_cmp_lt_u32 s26, 4
    s_cbranch_scc0 sequential_preLN__ssm_conv_s4__mixer_channel_mlp__prompt_kernel_ncw
    s_getpc_b64 s[62:63]
    s_and_b32 s62, s62, 0xffffff00
    v_lshlrev_b32 v6, 7, v0
    v_min_u32 v6, (sequential_preLN__ssm_conv_s4__mixer_channel_mlp__prompt_kernel_end - sequential_preLN__ssm_conv_s4__mixer_channel_mlp__prompt_kernel - 1024), v6
    global_load_dword v250, v6, s[62:63]
    v_add_u32 v6, 32768, v6
    v_min_u32 v6, (sequential_preLN__ssm_conv_s4__mixer_channel_mlp__prompt_kernel_end - sequential_preLN__ssm_conv_s4__mixer_channel_mlp__prompt_kernel - 1024), v6
    global_load_dword v251, v6, s[62:63]
sequential_preLN__ssm_conv_s4__mixer_channel_mlp__prompt_kernel_ncw:
    s_cmp_eq_u32 s22, 1
    s_cbranch_scc0 sequential_preLN__ssm_conv_s4__mixer_channel_mlp__prompt_kernel_ntlb
    v_min_u32 v6, 9, v2
    v_lshlrev_b32 v6, 21, v6
    v_add_u32 v6, 0x1000, v6
    global_load_dword v252, v6, s[20:21]
    v_mov_b32 v6, 0
    global_load_dword v253, v6, s[36:37]
    global_load_dword v254, v6, s[28:29]
    global_load_dword v255, v6, s[32:33]
sequential_preLN__ssm_conv_s4__mixer_channel_mlp__prompt_kernel_ntlb:
    v_mov_b32 v50, 0
    v_mov_b32 v51, 0
    v_mov_b32 v52, 0
    v_mov_b32 v53, 0
    v_lshlrev_b32 v55, 4, v0
    v_add_u32 v55, 131072, v55
    v_cmp_gt_u32 vcc, 30, v0
    s_nop 0
    s_and_saveexec_b64 s[52:53], vcc
    ds_write_b128 v55, v[50:53]
    ds_write_b128 v55, v[50:53] offset:4608
    s_mov_b64 exec, s[52:53]
    v_cmp_gt_u32 vcc, 2, v0
    s_nop 0
    s_and_saveexec_b64 s[52:53], vcc
    ds_write_b128 v55, v[50:53] offset:13344
    ds_write_b128 v55, v[50:53] offset:17504
    ds_write_b128 v55, v[50:53] offset:21664
    ds_write_b128 v55, v[50:53] offset:25824
    s_mov_b64 exec, s[52:53]
    v_bfe_u32 v50, v2, 2, 2
    v_lshl_add_u32 v51, v4, 3, v50
    v_lshlrev_b32 v51, 7, v51
    v_and_b32 v52, 3, v2
    v_lshlrev_b32 v52, 3, v52
    s_lshl_b32 s42, s22, 5
    s_add_u32 s42, s42, 114688
    v_add3_u32 v51, v51, v52, s42
    s_lshl_b32 s42, s23, 6
    s_lshl_b32 s43, s22, 4
    s_add_u32 s42, s42, s43
    v_add_u32 v53, s42, v3
    v_lshlrev_b32 v53, 12, v53
    v_lshlrev_b32 v54, 4, v4
    s_lshl_b32 s42, s26, 7
    s_add_u32 s42, s42, 3145728
    v_add3_u32 v53, v53, v54, s42
    s_lshl_b32 s47, s26, 2
    s_add_u32 s47, s47, s22
    v_lshrrev_b32 v56, 3, v2
    s_lshl_b32 s48, s47, 5
    v_add_u32 v56, s48, v56
    v_lshlrev_b32 v56, 10, v56
    v_and_b32 v57, 7, v2
    v_lshlrev_b32 v57, 4, v57
    s_lshl_b32 s48, s23, 7
    v_add3_u32 v56, v56, v57, s48
    s_lshl_b32 s49, s22, 12
    s_add_u32 s49, s49, 68928
    s_lshr_b32 s55, s26, 1
    s_waitcnt vmcnt(12) lgkmcnt(0)
    s_barrier
    ds_read_b64_tr_b16 v[96:97], v51
    ds_read_b64_tr_b16 v[98:99], v51 offset:512
    ds_read_b64_tr_b16 v[100:101], v51 offset:4096
    ds_read_b64_tr_b16 v[102:103], v51 offset:4608
    s_waitcnt lgkmcnt(0)
    global_store_dwordx4 v53, v[96:99], s[20:21] sc1
    global_store_dwordx4 v53, v[100:103], s[20:21] offset:64 sc1
    v_lshlrev_b32 v64, 16, v8
    v_and_b32 v65, 0xffff0000, v8
    v_lshlrev_b32 v66, 16, v9
    v_and_b32 v67, 0xffff0000, v9
    v_lshlrev_b32 v68, 16, v10
    v_and_b32 v69, 0xffff0000, v10
    v_lshlrev_b32 v70, 16, v11
    v_and_b32 v71, 0xffff0000, v11
    v_lshlrev_b32 v72, 16, v12
    v_and_b32 v73, 0xffff0000, v12
    v_lshlrev_b32 v74, 16, v13
    v_and_b32 v75, 0xffff0000, v13
    v_lshlrev_b32 v76, 16, v14
    v_and_b32 v77, 0xffff0000, v14
    v_lshlrev_b32 v78, 16, v15
    v_and_b32 v79, 0xffff0000, v15
    s_cmp_lt_u32 s2, 112
    s_cbranch_scc0 sequential_preLN__ssm_conv_s4__mixer_channel_mlp__prompt_kernel_nw2
    s_add_u32 m0, s49, 0
    v_add_u32 v57, 0, v56
    global_load_lds_dwordx4 v57, s[32:33]
    s_add_u32 m0, s49, 1024
    v_add_u32 v57, 8192, v56
    global_load_lds_dwordx4 v57, s[32:33]
    s_add_u32 m0, s49, 2048
    v_add_u32 v57, 16384, v56
    global_load_lds_dwordx4 v57, s[32:33]
    s_add_u32 m0, s49, 3072
    v_add_u32 v57, 24576, v56
    global_load_lds_dwordx4 v57, s[32:33]
sequential_preLN__ssm_conv_s4__mixer_channel_mlp__prompt_kernel_nw2:
    v_add_f32 v80, v64, v65
    v_mul_f32 v84, v64, v64
    v_add_f32 v82, v66, v67
    v_mul_f32 v86, v65, v65
    v_add_f32 v81, v72, v73
    v_mul_f32 v85, v72, v72
    v_add_f32 v83, v74, v75
    v_mul_f32 v87, v73, v73
    v_fmac_f32 v84, v66, v66
    v_fmac_f32 v86, v67, v67
    v_add_f32 v80, v80, v68
    v_add_f32 v82, v82, v69
    v_fmac_f32 v85, v74, v74
    v_fmac_f32 v87, v75, v75
    v_add_f32 v81, v81, v76
    v_add_f32 v83, v83, v77
    v_fmac_f32 v84, v68, v68
    v_fmac_f32 v86, v69, v69
    v_add_f32 v80, v80, v70
    v_add_f32 v82, v82, v71
    v_fmac_f32 v85, v76, v76
    v_fmac_f32 v87, v77, v77
    v_add_f32 v81, v81, v78
    v_add_f32 v83, v83, v79
    v_fmac_f32 v84, v70, v70
    v_fmac_f32 v86, v71, v71
    v_fmac_f32 v85, v78, v78
    v_fmac_f32 v87, v79, v79
    v_add_f32 v80, v80, v82
    v_add_f32 v84, v84, v86
    v_add_f32 v81, v81, v83
    v_add_f32 v85, v85, v87
    v_add_f32_dpp v80, v80, v80 quad_perm:[1,0,3,2] row_mask:0xf bank_mask:0xf
    v_add_f32_dpp v81, v81, v81 quad_perm:[1,0,3,2] row_mask:0xf bank_mask:0xf
    v_add_f32_dpp v84, v84, v84 quad_perm:[1,0,3,2] row_mask:0xf bank_mask:0xf
    v_add_f32_dpp v85, v85, v85 quad_perm:[1,0,3,2] row_mask:0xf bank_mask:0xf
    v_add_f32_dpp v80, v80, v80 quad_perm:[2,3,0,1] row_mask:0xf bank_mask:0xf
    v_add_f32_dpp v81, v81, v81 quad_perm:[2,3,0,1] row_mask:0xf bank_mask:0xf
    v_add_f32_dpp v84, v84, v84 quad_perm:[2,3,0,1] row_mask:0xf bank_mask:0xf
    v_add_f32_dpp v85, v85, v85 quad_perm:[2,3,0,1] row_mask:0xf bank_mask:0xf
    v_add_f32_dpp v80, v80, v80 row_half_mirror row_mask:0xf bank_mask:0xf
    v_add_f32_dpp v81, v81, v81 row_half_mirror row_mask:0xf bank_mask:0xf
    v_add_f32_dpp v84, v84, v84 row_half_mirror row_mask:0xf bank_mask:0xf
    v_add_f32_dpp v85, v85, v85 row_half_mirror row_mask:0xf bank_mask:0xf
    v_add_f32_dpp v80, v80, v80 row_mirror row_mask:0xf bank_mask:0xf
    v_add_f32_dpp v81, v81, v81 row_mirror row_mask:0xf bank_mask:0xf
    v_add_f32_dpp v84, v84, v84 row_mirror row_mask:0xf bank_mask:0xf
    v_add_f32_dpp v85, v85, v85 row_mirror row_mask:0xf bank_mask:0xf
    v_mov_b32 v82, v80
    v_mov_b32 v83, v81
    v_mov_b32 v86, v84
    v_mov_b32 v87, v85
    v_permlane16_swap_b32 v80, v82
    v_permlane16_swap_b32 v81, v83
    v_permlane16_swap_b32 v84, v86
    v_permlane16_swap_b32 v85, v87
    v_add_f32 v80, v80, v82
    v_add_f32 v81, v81, v83
    v_add_f32 v84, v84, v86
    v_add_f32 v85, v85, v87
    v_mov_b32 v82, v80
    v_mov_b32 v83, v81
    v_mov_b32 v86, v84
    v_mov_b32 v87, v85
    v_permlane32_swap_b32 v80, v82
    v_permlane32_swap_b32 v81, v83
    v_permlane32_swap_b32 v84, v86
    v_permlane32_swap_b32 v85, v87
    v_add_f32 v80, v80, v82
    v_add_f32 v81, v81, v83
    v_add_f32 v84, v84, v86
    v_add_f32 v85, v85, v87
    v_mul_f32 v80, 0x3b000000, v80
    v_mul_f32 v84, 0x3b000000, v84
    v_mul_f32 v81, 0x3b000000, v81
    v_mul_f32 v85, 0x3b000000, v85
    v_fma_f32 v84, -v80, v80, v84
    v_fma_f32 v85, -v81, v81, v85
    v_max_f32 v84, 0, v84
    v_max_f32 v85, 0, v85
    v_cvt_pk_bf16_f32 v84, v84, v84
    v_cvt_pk_bf16_f32 v85, v85, v85
    v_lshlrev_b32 v84, 16, v84
    v_lshlrev_b32 v85, 16, v85
    v_add_f32 v84, 0x3727c5ac, v84
    v_add_f32 v85, 0x3727c5ac, v85
    v_cvt_pk_bf16_f32 v84, v84, v84
    v_cvt_pk_bf16_f32 v85, v85, v85
    v_lshlrev_b32 v84, 16, v84
    v_lshlrev_b32 v85, 16, v85
    v_sqrt_f32 v84, v84
    v_sqrt_f32 v85, v85
    s_mul_i32 s38, s38, 0x9e3779b1
    s_add_u32 s38, s38, 0x7f4a7c15
    v_cvt_pk_bf16_f32 v88, v80, v84
    v_cvt_pk_bf16_f32 v90, v81, v85
    v_mov_b32 v89, s38
    v_mov_b32 v91, s38
    s_lshl_b32 s50, s40, 3
    s_add_u32 s50, s50, 32768
    v_mov_b32 v92, s50
    s_cmp_lt_u32 s2, 112
    s_cbranch_scc1 sequential_preLN__ssm_conv_s4__mixer_channel_mlp__prompt_kernel_wq1
    s_waitcnt vmcnt(2)
    s_branch sequential_preLN__ssm_conv_s4__mixer_channel_mlp__prompt_kernel_wq2
sequential_preLN__ssm_conv_s4__mixer_channel_mlp__prompt_kernel_wq1:
    s_waitcnt vmcnt(6)
sequential_preLN__ssm_conv_s4__mixer_channel_mlp__prompt_kernel_wq2:
    v_and_b32 v24, 0xffff, v216
    v_lshrrev_b32 v25, 16, v216
    v_and_b32 v26, 0xffff, v217
    v_lshrrev_b32 v27, 16, v217
    v_and_b32 v28, 0xffff, v218
    v_lshrrev_b32 v29, 16, v218
    v_and_b32 v30, 0xffff, v219
    v_lshrrev_b32 v31, 16, v219
    v_and_b32 v32, 0xffff, v220
    v_and_b32 v40, 0xffff, v221
    v_lshrrev_b32 v41, 16, v221
    v_and_b32 v42, 0xffff, v222
    v_lshrrev_b32 v43, 16, v222
    v_and_b32 v44, 0xffff, v223
    v_lshrrev_b32 v45, 16, v223
    v_and_b32 v46, 0xffff, v224
    v_lshrrev_b32 v47, 16, v224
    s_mul_i32 s56, s55, 224
    v_add_u32 v232, s56, v225
    v_add_u32 v233, s56, v226
    v_add_u32 v234, s56, v227
    v_add_u32 v235, s56, v228
    v_add_u32 v236, s56, v229
    v_add_u32 v237, s56, v230
    v_add_u32 v238, s56, v231
    s_add_u32 s57, s22, 12
    s_mul_i32 s56, s57, 114688
    s_mul_i32 s57, s57, 7168
    v_lshlrev_b32 v16, 16, v16
    v_lshlrev_b32 v17, 16, v17
    v_lshlrev_b32 v18, 16, v18
    v_lshlrev_b32 v19, 16, v19
    v_lshlrev_b32 v20, 16, v20
    v_lshlrev_b32 v21, 16, v21
    v_lshlrev_b32 v22, 16, v22
    v_lshlrev_b32 v23, 16, v23
    v_mul_f32 v22, 0x3fb8aa3b, v22
    v_exp_f32 v22, v22
    s_nop 0
    v_cvt_pk_bf16_f32 v22, v22, v22
    v_lshlrev_b32 v22, 16, v22
    v_mul_f32 v16, v22, v16
    v_mul_f32 v17, v22, v17
    v_mul_f32 v18, v22, v18
    v_mul_f32 v19, v22, v19
    v_mul_f32 v16, 0x3fb8aa3b, v16
    v_mul_f32 v17, 0x3e22f983, v17
    v_mul_f32 v100, 1.0, v16
    v_mul_f32 v101, 1.0, v17
    v_mul_f32 v102, 0x41000000, v16
    v_mul_f32 v103, 0x41000000, v17
    v_mul_f32 v104, 0x42000000, v16
    v_mul_f32 v105, 0x42000000, v17
    v_mul_f32 v106, 0x43800000, v16
    v_mul_f32 v107, 0x43800000, v17
    v_pk_mul_f32 v[52:53], v[20:21], v[18:19] op_sel_hi:[1,0]
    v_pk_fma_f32 v[50:51], v[20:21], v[18:19], v[52:53] op_sel:[1,1,0] op_sel_hi:[0,1,1] neg_lo:[1,0,0]
    v_exp_f32 v100, v100
    v_fract_f32 v101, v101
    v_exp_f32 v102, v102
    v_fract_f32 v103, v103
    v_exp_f32 v104, v104
    v_fract_f32 v105, v105
    v_exp_f32 v106, v106
    v_fract_f32 v107, v107
    v_cos_f32 v56, v101
    v_sin_f32 v57, v101
    v_cos_f32 v62, v103
    v_sin_f32 v63, v103
    v_cos_f32 v64, v105
    v_sin_f32 v65, v105
    v_cos_f32 v66, v107
    v_sin_f32 v67, v107
    v_pk_mul_f32 v[56:57], v[56:57], v[100:101] op_sel_hi:[1,0]
    v_pk_mul_f32 v[62:63], v[62:63], v[102:103] op_sel_hi:[1,0]
    v_pk_mul_f32 v[64:65], v[64:65], v[104:105] op_sel_hi:[1,0]
    v_pk_mul_f32 v[66:67], v[66:67], v[106:107] op_sel_hi:[1,0]
    s_cmp_lt_u32 s2, 112
    s_cbranch_scc1 sequential_preLN__ssm_conv_s4__mixer_channel_mlp__prompt_kernel_wd1
    s_waitcnt vmcnt(0)
    s_branch sequential_preLN__ssm_conv_s4__mixer_channel_mlp__prompt_kernel_wd2
sequential_preLN__ssm_conv_s4__mixer_channel_mlp__prompt_kernel_wd1:
    s_waitcnt vmcnt(4)
sequential_preLN__ssm_conv_s4__mixer_channel_mlp__prompt_kernel_wd2:
    s_barrier
    s_mov_b64 s[52:53], exec
    s_mov_b64 exec, 1
    global_store_dwordx4 v92, v[88:91], s[20:21] sc1
    s_mov_b64 exec, s[52:53]
    s_cmp_eq_u32 s22, 0
    s_cbranch_scc0 sequential_preLN__ssm_conv_s4__mixer_channel_mlp__prompt_kernel_nmw0
    s_mul_i32 s45, s2, 7168
    v_min_u32 v6, 55, v2
    v_lshlrev_b32 v6, 7, v6
    v_add_u32 v6, s45, v6
    global_load_dword v250, v6, s[28:29]
sequential_preLN__ssm_conv_s4__mixer_channel_mlp__prompt_kernel_nmw0:
    s_cmp_eq_u32 s22, 1
    s_cbranch_scc0 sequential_preLN__ssm_conv_s4__mixer_channel_mlp__prompt_kernel_nmw1
    v_min_u32 v6, 27, v2
    v_lshlrev_b32 v6, 7, v6
    global_load_dword v251, v6, s[30:31]
sequential_preLN__ssm_conv_s4__mixer_channel_mlp__prompt_kernel_nmw1:
    s_cmp_eq_u32 s22, 2
    s_cbranch_scc0 sequential_preLN__ssm_conv_s4__mixer_channel_mlp__prompt_kernel_nmw
    v_min_u32 v6, 7, v2
    v_lshlrev_b32 v6, 7, v6
    global_load_dword v252, v6, s[34:35]
sequential_preLN__ssm_conv_s4__mixer_channel_mlp__prompt_kernel_nmw:
    s_mul_i32 s50, s22, 14416
    s_add_u32 s50, s50, 0
    v_lshlrev_b32 v34, 2, v2
    v_add_u32 v34, s50, v34
    v_mov_b32 v68, 1.0
    v_mov_b32 v69, 0
    v_mov_b32 v70, v62
    v_mov_b32 v71, v63
    v_mov_b32 v84, v50
    v_mov_b32 v85, v51
    v_pk_mul_f32 v[52:53], v[56:57], v[56:57] op_sel_hi:[1,0]
    v_pk_mul_f32 v[76:77], v[62:63], v[62:63] op_sel_hi:[1,0]
    v_pk_fma_f32 v[58:59], v[56:57], v[56:57], v[52:53] op_sel:[1,1,0] op_sel_hi:[0,1,1] neg_lo:[1,0,0]
    v_pk_fma_f32 v[72:73], v[62:63], v[62:63], v[76:77] op_sel:[1,1,0] op_sel_hi:[0,1,1] neg_lo:[1,0,0]
    v_pk_mul_f32 v[52:53], v[58:59], v[58:59] op_sel_hi:[1,0]
    v_pk_mul_f32 v[76:77], v[72:73], v[62:63] op_sel_hi:[1,0]
    v_pk_fma_f32 v[60:61], v[58:59], v[58:59], v[52:53] op_sel:[1,1,0] op_sel_hi:[0,1,1] neg_lo:[1,0,0]
    v_pk_fma_f32 v[74:75], v[72:73], v[62:63], v[76:77] op_sel:[1,1,0] op_sel_hi:[0,1,1] neg_lo:[1,0,0]
    v_cvt_pk_bf16_f32 v86, v68, -v69
    v_cvt_pk_bf16_f32 v87, v70, -v71
    v_pk_mul_f32 v[92:93], v[84:85], v[66:67] op_sel_hi:[1,0]
    s_add_u32 m0, s57, 0
    v_add_u32 v239, s56, v232
    global_load_lds_dwordx4 v239, s[28:29]
    v_cvt_pk_bf16_f32 v88, v72, -v73
    v_cvt_pk_bf16_f32 v90, v50, v51
    v_cvt_pk_bf16_f32 v89, v74, -v75
    v_pk_mul_f32 v[76:77], v[68:69], v[64:65] op_sel_hi:[1,0]
    v_pk_fma_f32 v[84:85], v[84:85], v[66:67], v[92:93] op_sel:[1,1,0] op_sel_hi:[0,1,1] neg_lo:[1,0,0]
    v_pk_mul_f32 v[78:79], v[70:71], v[64:65] op_sel_hi:[1,0]
    ds_write_b32 v34, v90 offset:0
    v_pk_mul_f32 v[80:81], v[72:73], v[64:65] op_sel_hi:[1,0]
    v_pk_mul_f32 v[82:83], v[74:75], v[64:65] op_sel_hi:[1,0]
    v_cvt_pk_bf16_f32 v91, v84, v85
    ds_write_b32 v34, v86 offset:5712
    v_pk_mul_f32 v[52:53], v[50:51], v[56:57] op_sel_hi:[1,0]
    ds_write_b32 v34, v87 offset:5984
    ds_write_b32 v34, v88 offset:6256
    ds_write_b32 v34, v91 offset:2176
    ds_write_b32 v34, v89 offset:6528
    v_pk_fma_f32 v[50:51], v[50:51], v[56:57], v[52:53] op_sel:[1,1,0] op_sel_hi:[0,1,1] neg_lo:[1,0,0]
    v_pk_fma_f32 v[68:69], v[68:69], v[64:65], v[76:77] op_sel:[1,1,0] op_sel_hi:[0,1,1] neg_lo:[1,0,0]
    v_pk_fma_f32 v[70:71], v[70:71], v[64:65], v[78:79] op_sel:[1,1,0] op_sel_hi:[0,1,1] neg_lo:[1,0,0]
    v_pk_mul_f32 v[96:97], v[84:85], v[58:59] op_sel_hi:[1,0]
    v_pk_fma_f32 v[72:73], v[72:73], v[64:65], v[80:81] op_sel:[1,1,0] op_sel_hi:[0,1,1] neg_lo:[1,0,0]
    v_cvt_pk_bf16_f32 v90, v50, v51
    v_pk_fma_f32 v[74:75], v[74:75], v[64:65], v[82:83] op_sel:[1,1,0] op_sel_hi:[0,1,1] neg_lo:[1,0,0]
    v_cvt_pk_bf16_f32 v86, v68, -v69
    v_pk_fma_f32 v[94:95], v[84:85], v[58:59], v[96:97] op_sel:[1,1,0] op_sel_hi:[0,1,1] neg_lo:[1,0,0]
    v_cvt_pk_bf16_f32 v87, v70, -v71
    s_add_u32 m0, s57, 1024
    v_add_u32 v239, s56, v233
    global_load_lds_dwordx4 v239, s[28:29]
    ds_write_b32 v34, v90 offset:272
    v_cvt_pk_bf16_f32 v88, v72, -v73
    v_cvt_pk_bf16_f32 v89, v74, -v75
    v_cvt_pk_bf16_f32 v98, v94, v95
    v_pk_mul_f32 v[76:77], v[68:69], v[64:65] op_sel_hi:[1,0]
    v_pk_mul_f32 v[52:53], v[50:51], v[56:57] op_sel_hi:[1,0]
    v_pk_mul_f32 v[78:79], v[70:71], v[64:65] op_sel_hi:[1,0]
    v_pk_mul_f32 v[80:81], v[72:73], v[64:65] op_sel_hi:[1,0]
    ds_write_b32 v34, v98 offset:2448
    v_pk_mul_f32 v[82:83], v[74:75], v[64:65] op_sel_hi:[1,0]
    v_pk_fma_f32 v[50:51], v[50:51], v[56:57], v[52:53] op_sel:[1,1,0] op_sel_hi:[0,1,1] neg_lo:[1,0,0]
    ds_write_b32 v34, v86 offset:6800
    ds_write_b32 v34, v87 offset:7072
    v_pk_mul_f32 v[96:97], v[94:95], v[58:59] op_sel_hi:[1,0]
    ds_write_b32 v34, v88 offset:7344
    v_cvt_pk_bf16_f32 v90, v50, v51
    ds_write_b32 v34, v89 offset:7616
    v_pk_fma_f32 v[68:69], v[68:69], v[64:65], v[76:77] op_sel:[1,1,0] op_sel_hi:[0,1,1] neg_lo:[1,0,0]
    v_pk_fma_f32 v[94:95], v[94:95], v[58:59], v[96:97] op_sel:[1,1,0] op_sel_hi:[0,1,1] neg_lo:[1,0,0]
    v_pk_fma_f32 v[70:71], v[70:71], v[64:65], v[78:79] op_sel:[1,1,0] op_sel_hi:[0,1,1] neg_lo:[1,0,0]
    ds_write_b32 v34, v90 offset:544
    v_pk_fma_f32 v[72:73], v[72:73], v[64:65], v[80:81] op_sel:[1,1,0] op_sel_hi:[0,1,1] neg_lo:[1,0,0]
    v_pk_fma_f32 v[74:75], v[74:75], v[64:65], v[82:83] op_sel:[1,1,0] op_sel_hi:[0,1,1] neg_lo:[1,0,0]
    v_cvt_pk_bf16_f32 v98, v94, v95
    v_cvt_pk_bf16_f32 v86, v68, -v69
    v_pk_mul_f32 v[52:53], v[50:51], v[56:57] op_sel_hi:[1,0]
    s_add_u32 m0, s57, 2048
    v_add_u32 v239, s56, v234
    global_load_lds_dwordx4 v239, s[28:29]
    v_cvt_pk_bf16_f32 v87, v70, -v71
    v_cvt_pk_bf16_f32 v88, v72, -v73
    ds_write_b32 v34, v98 offset:2720
    v_cvt_pk_bf16_f32 v89, v74, -v75
    v_pk_fma_f32 v[50:51], v[50:51], v[56:57], v[52:53] op_sel:[1,1,0] op_sel_hi:[0,1,1] neg_lo:[1,0,0]
    v_pk_mul_f32 v[76:77], v[68:69], v[64:65] op_sel_hi:[1,0]
    v_pk_mul_f32 v[78:79], v[70:71], v[64:65] op_sel_hi:[1,0]
    v_pk_mul_f32 v[96:97], v[94:95], v[58:59] op_sel_hi:[1,0]
    v_pk_mul_f32 v[80:81], v[72:73], v[64:65] op_sel_hi:[1,0]
    v_cvt_pk_bf16_f32 v90, v50, v51
    v_pk_mul_f32 v[82:83], v[74:75], v[64:65] op_sel_hi:[1,0]
    ds_write_b32 v34, v86 offset:7888
    v_pk_fma_f32 v[94:95], v[94:95], v[58:59], v[96:97] op_sel:[1,1,0] op_sel_hi:[0,1,1] neg_lo:[1,0,0]
    ds_write_b32 v34, v87 offset:8160
    ds_write_b32 v34, v90 offset:816
    ds_write_b32 v34, v88 offset:8432
    ds_write_b32 v34, v89 offset:8704
    v_cvt_pk_bf16_f32 v98, v94, v95
    v_pk_fma_f32 v[68:69], v[68:69], v[64:65], v[76:77] op_sel:[1,1,0] op_sel_hi:[0,1,1] neg_lo:[1,0,0]
    v_pk_mul_f32 v[52:53], v[50:51], v[56:57] op_sel_hi:[1,0]
    v_pk_fma_f32 v[70:71], v[70:71], v[64:65], v[78:79] op_sel:[1,1,0] op_sel_hi:[0,1,1] neg_lo:[1,0,0]
    v_pk_fma_f32 v[72:73], v[72:73], v[64:65], v[80:81] op_sel:[1,1,0] op_sel_hi:[0,1,1] neg_lo:[1,0,0]
    ds_write_b32 v34, v98 offset:2992
    v_pk_fma_f32 v[74:75], v[74:75], v[64:65], v[82:83] op_sel:[1,1,0] op_sel_hi:[0,1,1] neg_lo:[1,0,0]
    v_pk_fma_f32 v[50:51], v[50:51], v[56:57], v[52:53] op_sel:[1,1,0] op_sel_hi:[0,1,1] neg_lo:[1,0,0]
    v_cvt_pk_bf16_f32 v86, v68, -v69
    s_add_u32 m0, s57, 3072
    v_add_u32 v239, s56, v235
    global_load_lds_dwordx4 v239, s[28:29]
    v_cvt_pk_bf16_f32 v87, v70, -v71
    v_pk_mul_f32 v[92:93], v[84:85], v[66:67] op_sel_hi:[1,0]
    v_cvt_pk_bf16_f32 v88, v72, -v73
    v_cvt_pk_bf16_f32 v90, v50, v51
    v_cvt_pk_bf16_f32 v89, v74, -v75
    v_pk_mul_f32 v[76:77], v[68:69], v[64:65] op_sel_hi:[1,0]
    v_pk_fma_f32 v[84:85], v[84:85], v[66:67], v[92:93] op_sel:[1,1,0] op_sel_hi:[0,1,1] neg_lo:[1,0,0]
    v_pk_mul_f32 v[78:79], v[70:71], v[64:65] op_sel_hi:[1,0]
    ds_write_b32 v34, v90 offset:1088
    v_pk_mul_f32 v[80:81], v[72:73], v[64:65] op_sel_hi:[1,0]
    v_pk_mul_f32 v[82:83], v[74:75], v[64:65] op_sel_hi:[1,0]
    v_cvt_pk_bf16_f32 v91, v84, v85
    ds_write_b32 v34, v86 offset:8976
    v_pk_mul_f32 v[52:53], v[50:51], v[56:57] op_sel_hi:[1,0]
    ds_write_b32 v34, v87 offset:9248
    ds_write_b32 v34, v88 offset:9520
    ds_write_b32 v34, v91 offset:3264
    ds_write_b32 v34, v89 offset:9792
    v_pk_fma_f32 v[50:51], v[50:51], v[56:57], v[52:53] op_sel:[1,1,0] op_sel_hi:[0,1,1] neg_lo:[1,0,0]
    v_pk_fma_f32 v[68:69], v[68:69], v[64:65], v[76:77] op_sel:[1,1,0] op_sel_hi:[0,1,1] neg_lo:[1,0,0]
    v_pk_fma_f32 v[70:71], v[70:71], v[64:65], v[78:79] op_sel:[1,1,0] op_sel_hi:[0,1,1] neg_lo:[1,0,0]
    v_pk_mul_f32 v[96:97], v[84:85], v[60:61] op_sel_hi:[1,0]
    v_pk_fma_f32 v[72:73], v[72:73], v[64:65], v[80:81] op_sel:[1,1,0] op_sel_hi:[0,1,1] neg_lo:[1,0,0]
    v_cvt_pk_bf16_f32 v90, v50, v51
    v_pk_fma_f32 v[74:75], v[74:75], v[64:65], v[82:83] op_sel:[1,1,0] op_sel_hi:[0,1,1] neg_lo:[1,0,0]
    v_cvt_pk_bf16_f32 v86, v68, -v69
    s_add_u32 m0, s57, 4096
    v_add_u32 v239, s56, v236
    global_load_lds_dwordx4 v239, s[28:29]
    v_pk_fma_f32 v[94:95], v[84:85], v[60:61], v[96:97] op_sel:[1,1,0] op_sel_hi:[0,1,1] neg_lo:[1,0,0]
    v_cvt_pk_bf16_f32 v87, v70, -v71
    ds_write_b32 v34, v90 offset:1360
    v_cvt_pk_bf16_f32 v88, v72, -v73
    v_cvt_pk_bf16_f32 v89, v74, -v75
    v_cvt_pk_bf16_f32 v98, v94, v95
    v_pk_mul_f32 v[76:77], v[68:69], v[64:65] op_sel_hi:[1,0]
    v_pk_mul_f32 v[52:53], v[50:51], v[56:57] op_sel_hi:[1,0]
    v_pk_mul_f32 v[78:79], v[70:71], v[64:65] op_sel_hi:[1,0]
    v_pk_mul_f32 v[80:81], v[72:73], v[64:65] op_sel_hi:[1,0]
    ds_write_b32 v34, v98 offset:3536
    v_pk_mul_f32 v[82:83], v[74:75], v[64:65] op_sel_hi:[1,0]
    v_pk_fma_f32 v[50:51], v[50:51], v[56:57], v[52:53] op_sel:[1,1,0] op_sel_hi:[0,1,1] neg_lo:[1,0,0]
    ds_write_b32 v34, v86 offset:10064
    ds_write_b32 v34, v87 offset:10336
    v_pk_mul_f32 v[92:93], v[84:85], v[66:67] op_sel_hi:[1,0]
    ds_write_b32 v34, v88 offset:10608
    v_cvt_pk_bf16_f32 v90, v50, v51
    ds_write_b32 v34, v89 offset:10880
    v_pk_fma_f32 v[68:69], v[68:69], v[64:65], v[76:77] op_sel:[1,1,0] op_sel_hi:[0,1,1] neg_lo:[1,0,0]
    v_pk_fma_f32 v[84:85], v[84:85], v[66:67], v[92:93] op_sel:[1,1,0] op_sel_hi:[0,1,1] neg_lo:[1,0,0]
    v_pk_fma_f32 v[70:71], v[70:71], v[64:65], v[78:79] op_sel:[1,1,0] op_sel_hi:[0,1,1] neg_lo:[1,0,0]
    ds_write_b32 v34, v90 offset:1632
    v_pk_fma_f32 v[72:73], v[72:73], v[64:65], v[80:81] op_sel:[1,1,0] op_sel_hi:[0,1,1] neg_lo:[1,0,0]
    v_pk_fma_f32 v[74:75], v[74:75], v[64:65], v[82:83] op_sel:[1,1,0] op_sel_hi:[0,1,1] neg_lo:[1,0,0]
    v_cvt_pk_bf16_f32 v91, v84, v85
    s_add_u32 m0, s57, 5120
    v_add_u32 v239, s56, v237
    global_load_lds_dwordx4 v239, s[28:29]
    v_cvt_pk_bf16_f32 v86, v68, -v69
    v_pk_mul_f32 v[52:53], v[50:51], v[56:57] op_sel_hi:[1,0]
    v_cvt_pk_bf16_f32 v87, v70, -v71
    v_cvt_pk_bf16_f32 v88, v72, -v73
    ds_write_b32 v34, v91 offset:3808
    v_cvt_pk_bf16_f32 v89, v74, -v75
    v_pk_fma_f32 v[50:51], v[50:51], v[56:57], v[52:53] op_sel:[1,1,0] op_sel_hi:[0,1,1] neg_lo:[1,0,0]
    v_pk_mul_f32 v[76:77], v[68:69], v[64:65] op_sel_hi:[1,0]
    v_pk_mul_f32 v[78:79], v[70:71], v[64:65] op_sel_hi:[1,0]
    v_pk_mul_f32 v[96:97], v[84:85], v[60:61] op_sel_hi:[1,0]
    v_pk_mul_f32 v[80:81], v[72:73], v[64:65] op_sel_hi:[1,0]
    v_cvt_pk_bf16_f32 v90, v50, v51
    v_pk_mul_f32 v[82:83], v[74:75], v[64:65] op_sel_hi:[1,0]
    ds_write_b32 v34, v86 offset:11152
    v_pk_fma_f32 v[94:95], v[84:85], v[60:61], v[96:97] op_sel:[1,1,0] op_sel_hi:[0,1,1] neg_lo:[1,0,0]
    ds_write_b32 v34, v87 offset:11424
    ds_write_b32 v34, v90 offset:1904
    ds_write_b32 v34, v88 offset:11696
    ds_write_b32 v34, v89 offset:11968
    v_cvt_pk_bf16_f32 v98, v94, v95
    v_pk_fma_f32 v[68:69], v[68:69], v[64:65], v[76:77] op_sel:[1,1,0] op_sel_hi:[0,1,1] neg_lo:[1,0,0]
    ds_write_b32 v34, v98 offset:4080
    v_pk_fma_f32 v[70:71], v[70:71], v[64:65], v[78:79] op_sel:[1,1,0] op_sel_hi:[0,1,1] neg_lo:[1,0,0]
    v_pk_fma_f32 v[72:73], v[72:73], v[64:65], v[80:81] op_sel:[1,1,0] op_sel_hi:[0,1,1] neg_lo:[1,0,0]
    v_pk_mul_f32 v[92:93], v[84:85], v[66:67] op_sel_hi:[1,0]
    v_pk_fma_f32 v[74:75], v[74:75], v[64:65], v[82:83] op_sel:[1,1,0] op_sel_hi:[0,1,1] neg_lo:[1,0,0]
    s_add_u32 m0, s57, 6144
    v_add_u32 v239, s56, v238
    global_load_lds_dwordx4 v239, s[28:29]
    v_pk_fma_f32 v[84:85], v[84:85], v[66:67], v[92:93] op_sel:[1,1,0] op_sel_hi:[0,1,1] neg_lo:[1,0,0]
    v_cvt_pk_bf16_f32 v86, v68, -v69
    v_cvt_pk_bf16_f32 v87, v70, -v71
    v_cvt_pk_bf16_f32 v91, v84, v85
    v_cvt_pk_bf16_f32 v88, v72, -v73
    ds_write_b32 v34, v91 offset:4352
    v_cvt_pk_bf16_f32 v89, v74, -v75
    v_pk_mul_f32 v[76:77], v[68:69], v[64:65] op_sel_hi:[1,0]
    v_pk_mul_f32 v[92:93], v[84:85], v[66:67] op_sel_hi:[1,0]
    v_pk_mul_f32 v[78:79], v[70:71], v[64:65] op_sel_hi:[1,0]
    v_pk_fma_f32 v[84:85], v[84:85], v[66:67], v[92:93] op_sel:[1,1,0] op_sel_hi:[0,1,1] neg_lo:[1,0,0]
    v_pk_mul_f32 v[80:81], v[72:73], v[64:65] op_sel_hi:[1,0]
    v_pk_mul_f32 v[82:83], v[74:75], v[64:65] op_sel_hi:[1,0]
    v_cvt_pk_bf16_f32 v91, v84, v85
    ds_write_b32 v34, v86 offset:12240
    ds_write_b32 v34, v91 offset:4624
    ds_write_b32 v34, v87 offset:12512
    ds_write_b32 v34, v88 offset:12784
    v_pk_mul_f32 v[92:93], v[84:85], v[66:67] op_sel_hi:[1,0]
    ds_write_b32 v34, v89 offset:13056
    v_pk_fma_f32 v[84:85], v[84:85], v[66:67], v[92:93] op_sel:[1,1,0] op_sel_hi:[0,1,1] neg_lo:[1,0,0]
    v_pk_fma_f32 v[68:69], v[68:69], v[64:65], v[76:77] op_sel:[1,1,0] op_sel_hi:[0,1,1] neg_lo:[1,0,0]
    v_pk_fma_f32 v[70:71], v[70:71], v[64:65], v[78:79] op_sel:[1,1,0] op_sel_hi:[0,1,1] neg_lo:[1,0,0]
    v_cvt_pk_bf16_f32 v91, v84, v85
    v_pk_fma_f32 v[72:73], v[72:73], v[64:65], v[80:81] op_sel:[1,1,0] op_sel_hi:[0,1,1] neg_lo:[1,0,0]
    ds_write_b32 v34, v91 offset:4896
    v_pk_fma_f32 v[74:75], v[74:75], v[64:65], v[82:83] op_sel:[1,1,0] op_sel_hi:[0,1,1] neg_lo:[1,0,0]
    v_cvt_pk_bf16_f32 v86, v68, -v69
    v_pk_mul_f32 v[92:93], v[84:85], v[66:67] op_sel_hi:[1,0]
    v_cvt_pk_bf16_f32 v87, v70, -v71
    v_pk_fma_f32 v[84:85], v[84:85], v[66:67], v[92:93] op_sel:[1,1,0] op_sel_hi:[0,1,1] neg_lo:[1,0,0]
    v_cvt_pk_bf16_f32 v88, v72, -v73
    v_cvt_pk_bf16_f32 v89, v74, -v75
    v_cvt_pk_bf16_f32 v91, v84, v85
    ds_write_b32 v34, v86 offset:13328
    ds_write_b32 v34, v91 offset:5168
    ds_write_b32 v34, v87 offset:13600
    ds_write_b32 v34, v88 offset:13872
    v_pk_mul_f32 v[92:93], v[84:85], v[66:67] op_sel_hi:[1,0]
    ds_write_b32 v34, v89 offset:14144
    v_pk_fma_f32 v[84:85], v[84:85], v[66:67], v[92:93] op_sel:[1,1,0] op_sel_hi:[0,1,1] neg_lo:[1,0,0]
    v_cvt_pk_bf16_f32 v91, v84, v85
    ds_write_b32 v34, v91 offset:5440
    v_lshlrev_b32 v208, 6, v0
    v_add_u32 v208, 32768, v208
    global_load_dwordx4 v[192:195], v208, s[20:21] offset:0 sc1
    global_load_dwordx4 v[196:199], v208, s[20:21] offset:16 sc1
    global_load_dwordx4 v[200:203], v208, s[20:21] offset:32 sc1
    global_load_dwordx4 v[204:207], v208, s[20:21] offset:48 sc1
    v_mul_u32_u24 v38, 272, v3
    v_lshlrev_b32 v39, 4, v4
    v_add_u32 v38, v38, v39
    s_lshr_b32 s50, s22, 1
    s_mul_i32 s50, s50, 28832
    s_add_u32 s50, s50, 0
    v_add_u32 v35, s50, v38
    s_and_b32 s51, s22, 1
    s_mul_i32 s51, s51, 4352
    s_add_u32 s51, s51, 5712
    v_add_u32 v36, s51, v35
    s_waitcnt lgkmcnt(0)
    s_barrier
    ds_read_b128 v[88:91], v36 offset:0
    ds_read_b128 v[92:95], v35 offset:0
    ds_read_b128 v[96:99], v35 offset:4352
    ds_read_b128 v[100:103], v36 offset:64
    ds_read_b128 v[104:107], v35 offset:64
    ds_read_b128 v[108:111], v35 offset:4416
    ds_read_b128 v[112:115], v36 offset:128
    ds_read_b128 v[116:119], v35 offset:128
    ds_read_b128 v[120:123], v35 offset:4480
    ds_read_b128 v[124:127], v36 offset:192
    ds_read_b128 v[128:131], v35 offset:192
    ds_read_b128 v[132:135], v35 offset:4544
    ds_read_b128 v[136:139], v36 offset:14416
    ds_read_b128 v[140:143], v35 offset:14416
    ds_read_b128 v[144:147], v35 offset:18768
    ds_read_b128 v[148:151], v36 offset:14480
    ds_read_b128 v[152:155], v35 offset:14480
    ds_read_b128 v[156:159], v35 offset:18832
    ds_read_b128 v[160:163], v36 offset:14544
    ds_read_b128 v[164:167], v35 offset:14544
    ds_read_b128 v[168:171], v35 offset:18896
    ds_read_b128 v[172:175], v36 offset:14608
    ds_read_b128 v[176:179], v35 offset:14608
    ds_read_b128 v[180:183], v35 offset:18960
    s_waitcnt lgkmcnt(15)
    v_mfma_f32_16x16x32_bf16 v[184:187], v[92:95], v[88:91], 0
    v_mfma_f32_16x16x32_bf16 v[188:191], v[96:99], v[88:91], 0
    v_mfma_f32_16x16x32_bf16 v[184:187], v[104:107], v[100:103], v[184:187]
    v_mfma_f32_16x16x32_bf16 v[188:191], v[108:111], v[100:103], v[188:191]
    v_mfma_f32_16x16x32_bf16 v[184:187], v[116:119], v[112:115], v[184:187]
    v_mfma_f32_16x16x32_bf16 v[188:191], v[120:123], v[112:115], v[188:191]
    s_waitcnt lgkmcnt(13)
    v_mfma_f32_16x16x32_bf16 v[184:187], v[128:131], v[124:127], v[184:187]
    s_waitcnt lgkmcnt(12)
    v_mfma_f32_16x16x32_bf16 v[188:191], v[132:135], v[124:127], v[188:191]
    s_waitcnt lgkmcnt(10)
    v_mfma_f32_16x16x32_bf16 v[184:187], v[140:143], v[136:139], v[184:187]
    s_waitcnt lgkmcnt(9)
    v_mfma_f32_16x16x32_bf16 v[188:191], v[144:147], v[136:139], v[188:191]
    s_waitcnt lgkmcnt(7)
    v_mfma_f32_16x16x32_bf16 v[184:187], v[152:155], v[148:151], v[184:187]
    s_waitcnt lgkmcnt(6)
    v_mfma_f32_16x16x32_bf16 v[188:191], v[156:159], v[148:151], v[188:191]
    s_waitcnt lgkmcnt(4)
    v_mfma_f32_16x16x32_bf16 v[184:187], v[164:167], v[160:163], v[184:187]
    s_waitcnt lgkmcnt(3)
    v_mfma_f32_16x16x32_bf16 v[188:191], v[168:171], v[160:163], v[188:191]
    s_waitcnt lgkmcnt(1)
    v_mfma_f32_16x16x32_bf16 v[184:187], v[176:179], v[172:175], v[184:187]
    s_waitcnt lgkmcnt(0)
    v_mfma_f32_16x16x32_bf16 v[188:191], v[180:183], v[172:175], v[188:191]
    s_nop 5
    ds_write_b32 v40, v184
    ds_write_b32 v41, v185
    ds_write_b32 v42, v186
    ds_write_b32 v43, v187
    ds_write_b32 v44, v188
    ds_write_b32 v45, v189
    ds_write_b32 v46, v190
    ds_write_b32 v47, v191
    s_waitcnt lgkmcnt(0)
    s_barrier
    ds_read_b32 v64, v24 offset:0
    ds_read_b32 v65, v25 offset:0
    ds_read_b32 v66, v26 offset:0
    ds_read_b32 v67, v27 offset:0
    ds_read_b32 v68, v28 offset:0
    ds_read_b32 v69, v29 offset:0
    ds_read_b32 v70, v30 offset:0
    ds_read_b32 v71, v31 offset:0
    ds_read_b32 v72, v32 offset:0
    ds_read_b32 v73, v24 offset:2944
    ds_read_b32 v74, v25 offset:2944
    ds_read_b32 v75, v26 offset:2944
    ds_read_b32 v76, v27 offset:2944
    ds_read_b32 v77, v28 offset:2944
    ds_read_b32 v78, v29 offset:2944
    ds_read_b32 v79, v30 offset:2944
    ds_read_b32 v80, v31 offset:2944
    ds_read_b32 v81, v32 offset:2944
    v_lshlrev_b32 v54, 4, v0
    v_add_u32 v54, 140320, v54
    v_cmp_eq_u32 vcc, 255, v0
    s_waitcnt lgkmcnt(0)
    s_nop 0
    v_cndmask_b32_e64 v72, v72, 0, vcc
    v_cvt_pk_bf16_f32 v104, v64, v65
    v_cvt_pk_bf16_f32 v108, v65, v66
    v_cvt_pk_bf16_f32 v105, v66, v67
    v_cvt_pk_bf16_f32 v109, v67, v68
    v_cvt_pk_bf16_f32 v106, v68, v69
    v_cvt_pk_bf16_f32 v110, v69, v70
    v_cvt_pk_bf16_f32 v107, v70, v71
    v_cvt_pk_bf16_f32 v111, v71, v72
    ds_write_b128 v54, v[104:107] offset:0
    ds_write_b128 v54, v[108:111] offset:4160
    v_cndmask_b32_e64 v81, v81, 0, vcc
    v_cvt_pk_bf16_f32 v112, v73, v74
    v_cvt_pk_bf16_f32 v116, v74, v75
    v_cvt_pk_bf16_f32 v113, v75, v76
    v_cvt_pk_bf16_f32 v117, v76, v77
    v_cvt_pk_bf16_f32 v114, v77, v78
    v_cvt_pk_bf16_f32 v118, v78, v79
    v_cvt_pk_bf16_f32 v115, v79, v80
    v_cvt_pk_bf16_f32 v119, v80, v81
    ds_write_b128 v54, v[112:115] offset:8320
    ds_write_b128 v54, v[116:119] offset:12480
    s_waitcnt vmcnt(0)
    v_cmp_eq_u32 vcc, s38, v193
    v_cmp_eq_u32 s[52:53], s38, v195
    s_nop 0
    s_and_b64 vcc, vcc, s[52:53]
    v_cmp_eq_u32 s[52:53], s38, v197
    s_nop 0
    s_and_b64 vcc, vcc, s[52:53]
    v_cmp_eq_u32 s[52:53], s38, v199
    s_nop 0
    s_and_b64 vcc, vcc, s[52:53]
    v_cmp_eq_u32 s[52:53], s38, v201
    s_nop 0
    s_and_b64 vcc, vcc, s[52:53]
    v_cmp_eq_u32 s[52:53], s38, v203
    s_nop 0
    s_and_b64 vcc, vcc, s[52:53]
    v_cmp_eq_u32 s[52:53], s38, v205
    s_nop 0
    s_and_b64 vcc, vcc, s[52:53]
    v_cmp_eq_u32 s[52:53], s38, v207
    s_nop 0
    s_and_b64 vcc, vcc, s[52:53]
    s_cmp_eq_u64 vcc, -1
    s_cbranch_scc1 sequential_preLN__ssm_conv_s4__mixer_channel_mlp__prompt_kernel_p1_ok
    s_mov_b32 s79, 200000
sequential_preLN__ssm_conv_s4__mixer_channel_mlp__prompt_kernel_p1:
    global_load_dwordx4 v[192:195], v208, s[20:21] offset:0 sc1
    global_load_dwordx4 v[196:199], v208, s[20:21] offset:16 sc1
    global_load_dwordx4 v[200:203], v208, s[20:21] offset:32 sc1
    global_load_dwordx4 v[204:207], v208, s[20:21] offset:48 sc1
    s_waitcnt vmcnt(0)
    v_cmp_eq_u32 vcc, s38, v193
    v_cmp_eq_u32 s[52:53], s38, v195
    s_nop 0
    s_and_b64 vcc, vcc, s[52:53]
    v_cmp_eq_u32 s[52:53], s38, v197
    s_nop 0
    s_and_b64 vcc, vcc, s[52:53]
    v_cmp_eq_u32 s[52:53], s38, v199
    s_nop 0
    s_and_b64 vcc, vcc, s[52:53]
    v_cmp_eq_u32 s[52:53], s38, v201
    s_nop 0
    s_and_b64 vcc, vcc, s[52:53]
    v_cmp_eq_u32 s[52:53], s38, v203
    s_nop 0
    s_and_b64 vcc, vcc, s[52:53]
    v_cmp_eq_u32 s[52:53], s38, v205
    s_nop 0
    s_and_b64 vcc, vcc, s[52:53]
    v_cmp_eq_u32 s[52:53], s38, v207
    s_nop 0
    s_and_b64 vcc, vcc, s[52:53]
    s_cmp_eq_u64 vcc, -1
    s_cbranch_scc1 sequential_preLN__ssm_conv_s4__mixer_channel_mlp__prompt_kernel_p1_ok
    s_sub_u32 s79, s79, 1
    s_cmp_eq_u32 s79, 0
    s_cbranch_scc0 sequential_preLN__ssm_conv_s4__mixer_channel_mlp__prompt_kernel_p1
sequential_preLN__ssm_conv_s4__mixer_channel_mlp__prompt_kernel_p1_ok:
    s_lshl_b32 s45, s27, 13
    s_add_u32 s45, s45, 3145728
    v_lshlrev_b32 v5, 4, v0
    v_add_u32 v6, s45, v5
    v_add_u32 v7, 4096, v6
    global_load_dwordx4 v[80:83], v6, s[20:21] sc1
    global_load_dwordx4 v[84:87], v7, s[20:21] sc1
    s_lshr_b32 s55, s26, 1
    s_lshr_b32 s42, s22, 1
    s_and_b32 s44, s22, 1
    s_cmp_lt_u32 s2, 112
    s_cbranch_scc0 sequential_preLN__ssm_conv_s4__mixer_channel_mlp__prompt_kernel_nw2b
    v_bfe_u32 v50, v2, 2, 2
    v_and_b32 v52, 3, v2
    v_lshlrev_b32 v52, 3, v52
    v_lshl_add_u32 v50, v4, 2, v50
    v_lshlrev_b32 v50, 7, v50
    v_add3_u32 v50, v50, v52, s49
    s_mul_i32 s48, s23, 224
    s_add_u32 s48, s48, s47
    s_lshl_b32 s48, s48, 10
    s_add_u32 s48, s48, 9437184
    v_lshlrev_b32 v53, 4, v2
    v_add_u32 v53, s48, v53
    ds_read_b64_tr_b16 v[100:101], v50 offset:0
    ds_read_b64_tr_b16 v[102:103], v50 offset:2048
    ds_read_b64_tr_b16 v[104:105], v50 offset:32
    ds_read_b64_tr_b16 v[106:107], v50 offset:2080
    ds_read_b64_tr_b16 v[108:109], v50 offset:64
    ds_read_b64_tr_b16 v[110:111], v50 offset:2112
    ds_read_b64_tr_b16 v[112:113], v50 offset:96
    ds_read_b64_tr_b16 v[114:115], v50 offset:2144
    s_waitcnt lgkmcnt(0)
    v_add_u32 v54, 0, v53
    global_store_dwordx4 v54, v[100:103], s[20:21] sc1
    v_add_u32 v54, 57344, v53
    global_store_dwordx4 v54, v[104:107], s[20:21] sc1
    v_add_u32 v54, 114688, v53
    global_store_dwordx4 v54, v[108:111], s[20:21] sc1
    v_add_u32 v54, 172032, v53
    global_store_dwordx4 v54, v[112:115], s[20:21] sc1
sequential_preLN__ssm_conv_s4__mixer_channel_mlp__prompt_kernel_nw2b:
    s_mul_i32 s56, s22, 114688
    s_mul_i32 s57, s22, 7168
    v_add_u32 v232, s56, v232
    v_add_u32 v233, s56, v233
    v_add_u32 v234, s56, v234
    v_add_u32 v235, s56, v235
    v_add_u32 v236, s56, v236
    v_add_u32 v237, s56, v237
    v_add_u32 v238, s56, v238
    v_and_b32 v65, 0xffff0000, v192
    v_lshlrev_b32 v64, 16, v192
    v_rcp_f32 v65, v65
    v_and_b32 v67, 0xffff0000, v194
    v_lshlrev_b32 v66, 16, v194
    v_rcp_f32 v67, v67
    v_and_b32 v69, 0xffff0000, v196
    v_lshlrev_b32 v68, 16, v196
    v_rcp_f32 v69, v69
    v_and_b32 v71, 0xffff0000, v198
    v_lshlrev_b32 v70, 16, v198
    v_rcp_f32 v71, v71
    v_and_b32 v73, 0xffff0000, v200
    v_lshlrev_b32 v72, 16, v200
    v_rcp_f32 v73, v73
    v_and_b32 v75, 0xffff0000, v202
    v_lshlrev_b32 v74, 16, v202
    v_rcp_f32 v75, v75
    v_and_b32 v77, 0xffff0000, v204
    v_lshlrev_b32 v76, 16, v204
    v_rcp_f32 v77, v77
    v_and_b32 v79, 0xffff0000, v206
    v_lshlrev_b32 v78, 16, v206
    v_rcp_f32 v79, v79
    v_lshlrev_b32 v56, 5, v3
    v_lshlrev_b32 v57, 4, v4
    v_add_u32 v56, v56, v57
    s_lshl_b32 s45, s44, 8
    s_mul_i32 s46, s42, 4608
    s_sub_u32 s46, s46, s45
    s_add_u32 s46, s46, 131520
    v_add_u32 v60, s46, v56
    v_lshrrev_b32 v58, 1, v3
    v_lshlrev_b32 v58, 2, v58
    v_sub_u32 v58, v57, v58
    v_and_b32 v59, 1, v3
    v_sub_u32 v59, 1, v59
    v_mul_u32_u24 v59, 4160, v59
    v_add_u32 v58, v58, v59
    s_mul_i32 s46, s42, 8320
    s_sub_u32 s46, s46, s45
    s_add_u32 s46, s46, 144380
    v_add_u32 v58, s46, v58
    v_subrev_u32 v12, 512, v58
    v_subrev_u32 v13, 1536, v58
    v_subrev_u32 v14, 2560, v58
    v_subrev_u32 v15, 3584, v58
    s_cmp_lt_u32 s2, 112
    s_cbranch_scc1 sequential_preLN__ssm_conv_s4__mixer_channel_mlp__prompt_kernel_wx1
    s_waitcnt vmcnt(0)
    s_branch sequential_preLN__ssm_conv_s4__mixer_channel_mlp__prompt_kernel_wx2
sequential_preLN__ssm_conv_s4__mixer_channel_mlp__prompt_kernel_wx1:
    s_waitcnt vmcnt(4)
sequential_preLN__ssm_conv_s4__mixer_channel_mlp__prompt_kernel_wx2:
    v_lshlrev_b32 v88, 16, v80
    v_and_b32 v89, 0xffff0000, v80
    v_lshlrev_b32 v90, 16, v81
    v_and_b32 v91, 0xffff0000, v81
    v_lshlrev_b32 v92, 16, v82
    v_and_b32 v93, 0xffff0000, v82
    v_lshlrev_b32 v94, 16, v83
    v_and_b32 v95, 0xffff0000, v83
    v_lshlrev_b32 v96, 16, v84
    v_and_b32 v97, 0xffff0000, v84
    v_lshlrev_b32 v98, 16, v85
    v_and_b32 v99, 0xffff0000, v85
    v_lshlrev_b32 v100, 16, v86
    v_and_b32 v101, 0xffff0000, v86
    v_lshlrev_b32 v102, 16, v87
    v_and_b32 v103, 0xffff0000, v87
    v_sub_f32 v88, v88, v64
    v_sub_f32 v96, v96, v64
    v_sub_f32 v89, v89, v66
    v_sub_f32 v97, v97, v66
    v_sub_f32 v90, v90, v68
    v_sub_f32 v98, v98, v68
    v_sub_f32 v91, v91, v70
    v_sub_f32 v99, v99, v70
    v_sub_f32 v92, v92, v72
    v_sub_f32 v100, v100, v72
    v_sub_f32 v93, v93, v74
    v_sub_f32 v101, v101, v74
    v_sub_f32 v94, v94, v76
    v_sub_f32 v102, v102, v76
    v_sub_f32 v95, v95, v78
    v_sub_f32 v103, v103, v78
    v_cvt_pk_bf16_f32 v104, v88, v89
    v_cvt_pk_bf16_f32 v105, v90, v91
    v_cvt_pk_bf16_f32 v106, v92, v93
    v_cvt_pk_bf16_f32 v107, v94, v95
    v_cvt_pk_bf16_f32 v108, v96, v97
    v_cvt_pk_bf16_f32 v109, v98, v99
    v_cvt_pk_bf16_f32 v110, v100, v101
    v_cvt_pk_bf16_f32 v111, v102, v103
    v_lshlrev_b32 v88, 16, v104
    v_and_b32 v89, 0xffff0000, v104
    v_lshlrev_b32 v90, 16, v105
    v_and_b32 v91, 0xffff0000, v105
    v_lshlrev_b32 v92, 16, v106
    v_and_b32 v93, 0xffff0000, v106
    v_lshlrev_b32 v94, 16, v107
    v_and_b32 v95, 0xffff0000, v107
    v_lshlrev_b32 v96, 16, v108
    v_and_b32 v97, 0xffff0000, v108
    v_lshlrev_b32 v98, 16, v109
    v_and_b32 v99, 0xffff0000, v109
    v_lshlrev_b32 v100, 16, v110
    v_and_b32 v101, 0xffff0000, v110
    v_lshlrev_b32 v102, 16, v111
    v_and_b32 v103, 0xffff0000, v111
    v_mul_f32 v88, v88, v65
    v_mul_f32 v96, v96, v65
    v_mul_f32 v89, v89, v67
    v_mul_f32 v97, v97, v67
    v_mul_f32 v90, v90, v69
    v_mul_f32 v98, v98, v69
    v_mul_f32 v91, v91, v71
    v_mul_f32 v99, v99, v71
    v_mul_f32 v92, v92, v73
    v_mul_f32 v100, v100, v73
    v_mul_f32 v93, v93, v75
    v_mul_f32 v101, v101, v75
    v_mul_f32 v94, v94, v77
    v_mul_f32 v102, v102, v77
    v_mul_f32 v95, v95, v79
    v_mul_f32 v103, v103, v79
    v_cvt_pk_bf16_f32 v104, v88, v89
    v_cvt_pk_bf16_f32 v105, v90, v91
    v_cvt_pk_bf16_f32 v106, v92, v93
    v_cvt_pk_bf16_f32 v107, v94, v95
    v_cvt_pk_bf16_f32 v108, v96, v97
    v_cvt_pk_bf16_f32 v109, v98, v99
    v_cvt_pk_bf16_f32 v110, v100, v101
    v_cvt_pk_bf16_f32 v111, v102, v103
    v_add_u32 v5, 131552, v5
    ds_write_b128 v5, v[104:107]
    ds_write_b128 v5, v[108:111] offset:4608
    s_waitcnt lgkmcnt(0)
    s_barrier
    v_lshlrev_b32 v56, 5, v3
    v_lshlrev_b32 v57, 3, v4
    v_add_u32 v56, v56, v57
    s_lshl_b32 s45, s44, 11
    s_lshl_b32 s46, s27, 1
    s_add_u32 s46, s46, s42
    s_lshl_b32 s46, s46, 12
    s_add_u32 s46, s46, s45
    s_add_u32 s46, s46, 3145728
    v_add_u32 v59, s46, v56
    global_load_dwordx2 v[240:241], v59, s[20:21] offset:0 sc1
    global_load_dwordx2 v[242:243], v59, s[20:21] offset:512 sc1
    global_load_dwordx2 v[244:245], v59, s[20:21] offset:1024 sc1
    global_load_dwordx2 v[246:247], v59, s[20:21] offset:1536 sc1
    s_and_b32 s59, s26, 7
    s_mul_i32 s45, s59, 224
    s_mul_i32 s46, s22, 14
    s_add_u32 s45, s45, s46
    s_lshl_b32 s45, s45, 10
    s_add_u32 s45, s45, 9437184
    v_lshlrev_b32 v6, 4, v2
    v_add_u32 v8, s45, v6
    s_lshl_b32 s45, s2, 6
    s_lshl_b32 s46, s22, 2
    s_add_u32 s45, s45, s46
    s_add_u32 s45, s45, 98304
    v_mov_b32 v10, s45
    v_mov_b32 v11, s38
    ds_read2_b32 v[104:105], v12 offset0:128 offset1:129
    ds_read2_b32 v[106:107], v12 offset0:130 offset1:131
    ds_read_b128 v[72:75], v60 offset:0
    ds_read_b128 v[76:79], v60 offset:512
    ds_read_b128 v[80:83], v60 offset:1024
    ds_read_b128 v[84:87], v60 offset:1536
    ds_read_b128 v[88:91], v60 offset:2048
    ds_read_b128 v[92:95], v60 offset:2560
    ds_read_b128 v[96:99], v60 offset:3072
    ds_read_b128 v[100:103], v60 offset:3584
    ds_read2_b32 v[108:109], v12 offset0:0 offset1:1
    ds_read2_b32 v[110:111], v12 offset0:2 offset1:3
    ds_read2_b32 v[112:113], v13 offset0:128 offset1:129
    ds_read2_b32 v[114:115], v13 offset0:130 offset1:131
    ds_read2_b32 v[116:117], v13 offset0:0 offset1:1
    ds_read2_b32 v[118:119], v13 offset0:2 offset1:3
    ds_read2_b32 v[120:121], v14 offset0:128 offset1:129
    ds_read2_b32 v[122:123], v14 offset0:130 offset1:131
    ds_read2_b32 v[124:125], v14 offset0:0 offset1:1
    ds_read2_b32 v[126:127], v14 offset0:2 offset1:3
    ds_read2_b32 v[128:129], v15 offset0:128 offset1:129
    ds_read2_b32 v[130:131], v15 offset0:130 offset1:131
    ds_read2_b32 v[132:133], v15 offset0:0 offset1:1
    ds_read2_b32 v[134:135], v15 offset0:2 offset1:3
    v_subrev_u32 v60, 64, v60
    v_subrev_u32 v12, 64, v12
    v_subrev_u32 v13, 64, v13
    v_subrev_u32 v14, 64, v14
    v_subrev_u32 v15, 64, v15
    s_waitcnt lgkmcnt(15)
    v_mfma_f32_16x16x32_bf16 v[200:203], v[104:107], v[72:75], 0
    ds_read2_b32 v[168:169], v12 offset0:128 offset1:129
    v_mfma_f32_16x16x32_bf16 v[204:207], v[104:107], v[76:79], 0
    ds_read2_b32 v[170:171], v12 offset0:130 offset1:131
    v_mfma_f32_16x16x32_bf16 v[208:211], v[104:107], v[80:83], 0
    ds_read_b128 v[136:139], v60 offset:0
    v_mfma_f32_16x16x32_bf16 v[212:215], v[104:107], v[84:87], 0
    ds_read_b128 v[140:143], v60 offset:512
    v_mfma_f32_16x16x32_bf16 v[216:219], v[104:107], v[88:91], 0
    ds_read_b128 v[144:147], v60 offset:1024
    v_mfma_f32_16x16x32_bf16 v[220:223], v[104:107], v[92:95], 0
    ds_read_b128 v[148:151], v60 offset:1536
    s_add_u32 m0, s57, 0
    s_nop 0
    global_load_lds_dwordx4 v232, s[28:29]
    v_add_u32 v232, 458752, v232
    v_mfma_f32_16x16x32_bf16 v[224:227], v[104:107], v[96:99], 0
    ds_read_b128 v[152:155], v60 offset:2048
    s_waitcnt lgkmcnt(15)
    v_mfma_f32_16x16x32_bf16 v[228:231], v[104:107], v[100:103], 0
    ds_read_b128 v[156:159], v60 offset:2560
    v_mfma_f32_16x16x32_bf16 v[204:207], v[108:111], v[72:75], v[204:207]
    ds_read_b128 v[160:163], v60 offset:3072
    v_mfma_f32_16x16x32_bf16 v[208:211], v[108:111], v[76:79], v[208:211]
    ds_read_b128 v[164:167], v60 offset:3584
    v_mfma_f32_16x16x32_bf16 v[212:215], v[108:111], v[80:83], v[212:215]
    ds_read2_b32 v[172:173], v12 offset0:0 offset1:1
    v_mfma_f32_16x16x32_bf16 v[216:219], v[108:111], v[84:87], v[216:219]
    ds_read2_b32 v[174:175], v12 offset0:2 offset1:3
    s_add_u32 m0, s57, 1024
    s_nop 0
    global_load_lds_dwordx4 v233, s[28:29]
    v_add_u32 v233, 458752, v233
    v_mfma_f32_16x16x32_bf16 v[220:223], v[108:111], v[88:91], v[220:223]
    ds_read2_b32 v[176:177], v13 offset0:128 offset1:129
    v_mfma_f32_16x16x32_bf16 v[224:227], v[108:111], v[92:95], v[224:227]
    ds_read2_b32 v[178:179], v13 offset0:130 offset1:131
    v_mfma_f32_16x16x32_bf16 v[228:231], v[108:111], v[96:99], v[228:231]
    ds_read2_b32 v[180:181], v13 offset0:0 offset1:1
    v_mfma_f32_16x16x32_bf16 v[208:211], v[112:115], v[72:75], v[208:211]
    ds_read2_b32 v[182:183], v13 offset0:2 offset1:3
    v_mfma_f32_16x16x32_bf16 v[212:215], v[112:115], v[76:79], v[212:215]
    ds_read2_b32 v[184:185], v14 offset0:128 offset1:129
    v_mfma_f32_16x16x32_bf16 v[216:219], v[112:115], v[80:83], v[216:219]
    ds_read2_b32 v[186:187], v14 offset0:130 offset1:131
    s_add_u32 m0, s57, 2048
    s_nop 0
    global_load_lds_dwordx4 v234, s[28:29]
    v_add_u32 v234, 458752, v234
    v_mfma_f32_16x16x32_bf16 v[220:223], v[112:115], v[84:87], v[220:223]
    ds_read2_b32 v[188:189], v14 offset0:0 offset1:1
    v_mfma_f32_16x16x32_bf16 v[224:227], v[112:115], v[88:91], v[224:227]
    ds_read2_b32 v[190:191], v14 offset0:2 offset1:3
    v_mfma_f32_16x16x32_bf16 v[228:231], v[112:115], v[92:95], v[228:231]
    ds_read2_b32 v[192:193], v15 offset0:128 offset1:129
    v_mfma_f32_16x16x32_bf16 v[212:215], v[116:119], v[72:75], v[212:215]
    ds_read2_b32 v[194:195], v15 offset0:130 offset1:131
    v_mfma_f32_16x16x32_bf16 v[216:219], v[116:119], v[76:79], v[216:219]
    ds_read2_b32 v[196:197], v15 offset0:0 offset1:1
    v_mfma_f32_16x16x32_bf16 v[220:223], v[116:119], v[80:83], v[220:223]
    ds_read2_b32 v[198:199], v15 offset0:2 offset1:3
    s_add_u32 m0, s57, 3072
    s_nop 0
    global_load_lds_dwordx4 v235, s[28:29]
    v_add_u32 v235, 458752, v235
    v_mfma_f32_16x16x32_bf16 v[224:227], v[116:119], v[84:87], v[224:227]
    v_subrev_u32 v60, 64, v60
    v_mfma_f32_16x16x32_bf16 v[228:231], v[116:119], v[88:91], v[228:231]
    v_subrev_u32 v12, 64, v12
    s_waitcnt lgkmcnt(15)
    v_mfma_f32_16x16x32_bf16 v[216:219], v[120:123], v[72:75], v[216:219]
    v_subrev_u32 v13, 64, v13
    v_mfma_f32_16x16x32_bf16 v[220:223], v[120:123], v[76:79], v[220:223]
    v_subrev_u32 v14, 64, v14
    v_mfma_f32_16x16x32_bf16 v[224:227], v[120:123], v[80:83], v[224:227]
    v_subrev_u32 v15, 64, v15
    v_mfma_f32_16x16x32_bf16 v[228:231], v[120:123], v[84:87], v[228:231]
    s_add_u32 m0, s57, 4096
    s_nop 0
    global_load_lds_dwordx4 v236, s[28:29]
    v_add_u32 v236, 458752, v236
    v_mfma_f32_16x16x32_bf16 v[220:223], v[124:127], v[72:75], v[220:223]
    v_mfma_f32_16x16x32_bf16 v[224:227], v[124:127], v[76:79], v[224:227]
    v_mfma_f32_16x16x32_bf16 v[228:231], v[124:127], v[80:83], v[228:231]
    v_mfma_f32_16x16x32_bf16 v[224:227], v[128:131], v[72:75], v[224:227]
    v_mfma_f32_16x16x32_bf16 v[228:231], v[128:131], v[76:79], v[228:231]
    v_mfma_f32_16x16x32_bf16 v[228:231], v[132:135], v[72:75], v[228:231]
    s_add_u32 m0, s57, 5120
    s_nop 0
    global_load_lds_dwordx4 v237, s[28:29]
    v_add_u32 v237, 458752, v237
    v_mfma_f32_16x16x32_bf16 v[200:203], v[168:171], v[136:139], v[200:203]
    ds_read2_b32 v[104:105], v12 offset0:128 offset1:129
    v_mfma_f32_16x16x32_bf16 v[204:207], v[168:171], v[140:143], v[204:207]
    ds_read2_b32 v[106:107], v12 offset0:130 offset1:131
    v_mfma_f32_16x16x32_bf16 v[208:211], v[168:171], v[144:147], v[208:211]
    ds_read_b128 v[72:75], v60 offset:0
    v_mfma_f32_16x16x32_bf16 v[212:215], v[168:171], v[148:151], v[212:215]
    ds_read_b128 v[76:79], v60 offset:512
    v_mfma_f32_16x16x32_bf16 v[216:219], v[168:171], v[152:155], v[216:219]
    ds_read_b128 v[80:83], v60 offset:1024
    v_mfma_f32_16x16x32_bf16 v[220:223], v[168:171], v[156:159], v[220:223]
    ds_read_b128 v[84:87], v60 offset:1536
    s_add_u32 m0, s57, 6144
    s_nop 0
    global_load_lds_dwordx4 v238, s[28:29]
    v_add_u32 v238, 458752, v238
    v_mfma_f32_16x16x32_bf16 v[224:227], v[168:171], v[160:163], v[224:227]
    ds_read_b128 v[88:91], v60 offset:2048
    s_waitcnt lgkmcnt(15)
    v_mfma_f32_16x16x32_bf16 v[228:231], v[168:171], v[164:167], v[228:231]
    ds_read_b128 v[92:95], v60 offset:2560
    v_mfma_f32_16x16x32_bf16 v[204:207], v[172:175], v[136:139], v[204:207]
    ds_read_b128 v[96:99], v60 offset:3072
    v_mfma_f32_16x16x32_bf16 v[208:211], v[172:175], v[140:143], v[208:211]
    ds_read_b128 v[100:103], v60 offset:3584
    v_mfma_f32_16x16x32_bf16 v[212:215], v[172:175], v[144:147], v[212:215]
    ds_read2_b32 v[108:109], v12 offset0:0 offset1:1
    v_mfma_f32_16x16x32_bf16 v[216:219], v[172:175], v[148:151], v[216:219]
    ds_read2_b32 v[110:111], v12 offset0:2 offset1:3
    s_add_u32 m0, s57, 28672
    s_nop 0
    global_load_lds_dwordx4 v232, s[28:29]
    v_add_u32 v232, 458752, v232
    v_mfma_f32_16x16x32_bf16 v[220:223], v[172:175], v[152:155], v[220:223]
    ds_read2_b32 v[112:113], v13 offset0:128 offset1:129
    v_mfma_f32_16x16x32_bf16 v[224:227], v[172:175], v[156:159], v[224:227]
    ds_read2_b32 v[114:115], v13 offset0:130 offset1:131
    v_mfma_f32_16x16x32_bf16 v[228:231], v[172:175], v[160:163], v[228:231]
    ds_read2_b32 v[116:117], v13 offset0:0 offset1:1
    v_mfma_f32_16x16x32_bf16 v[208:211], v[176:179], v[136:139], v[208:211]
    ds_read2_b32 v[118:119], v13 offset0:2 offset1:3
    v_mfma_f32_16x16x32_bf16 v[212:215], v[176:179], v[140:143], v[212:215]
    ds_read2_b32 v[120:121], v14 offset0:128 offset1:129
    v_mfma_f32_16x16x32_bf16 v[216:219], v[176:179], v[144:147], v[216:219]
    ds_read2_b32 v[122:123], v14 offset0:130 offset1:131
    s_add_u32 m0, s57, 29696
    s_nop 0
    global_load_lds_dwordx4 v233, s[28:29]
    v_add_u32 v233, 458752, v233
    v_mfma_f32_16x16x32_bf16 v[220:223], v[176:179], v[148:151], v[220:223]
    ds_read2_b32 v[124:125], v14 offset0:0 offset1:1
    v_mfma_f32_16x16x32_bf16 v[224:227], v[176:179], v[152:155], v[224:227]
    ds_read2_b32 v[126:127], v14 offset0:2 offset1:3
    v_mfma_f32_16x16x32_bf16 v[228:231], v[176:179], v[156:159], v[228:231]
    ds_read2_b32 v[128:129], v15 offset0:128 offset1:129
    v_mfma_f32_16x16x32_bf16 v[212:215], v[180:183], v[136:139], v[212:215]
    ds_read2_b32 v[130:131], v15 offset0:130 offset1:131
    v_mfma_f32_16x16x32_bf16 v[216:219], v[180:183], v[140:143], v[216:219]
    ds_read2_b32 v[132:133], v15 offset0:0 offset1:1
    v_mfma_f32_16x16x32_bf16 v[220:223], v[180:183], v[144:147], v[220:223]
    ds_read2_b32 v[134:135], v15 offset0:2 offset1:3
    s_add_u32 m0, s57, 30720
    s_nop 0
    global_load_lds_dwordx4 v234, s[28:29]
    v_add_u32 v234, 458752, v234
    v_mfma_f32_16x16x32_bf16 v[224:227], v[180:183], v[148:151], v[224:227]
    v_subrev_u32 v60, 64, v60
    v_mfma_f32_16x16x32_bf16 v[228:231], v[180:183], v[152:155], v[228:231]
    v_subrev_u32 v12, 64, v12
    s_waitcnt lgkmcnt(15)
    v_mfma_f32_16x16x32_bf16 v[216:219], v[184:187], v[136:139], v[216:219]
    v_subrev_u32 v13, 64, v13
    v_mfma_f32_16x16x32_bf16 v[220:223], v[184:187], v[140:143], v[220:223]
    v_subrev_u32 v14, 64, v14
    v_mfma_f32_16x16x32_bf16 v[224:227], v[184:187], v[144:147], v[224:227]
    v_subrev_u32 v15, 64, v15
    v_mfma_f32_16x16x32_bf16 v[228:231], v[184:187], v[148:151], v[228:231]
    s_add_u32 m0, s57, 31744
    s_nop 0
    global_load_lds_dwordx4 v235, s[28:29]
    v_add_u32 v235, 458752, v235
    v_mfma_f32_16x16x32_bf16 v[220:223], v[188:191], v[136:139], v[220:223]
    v_mfma_f32_16x16x32_bf16 v[224:227], v[188:191], v[140:143], v[224:227]
    v_mfma_f32_16x16x32_bf16 v[228:231], v[188:191], v[144:147], v[228:231]
    v_mfma_f32_16x16x32_bf16 v[224:227], v[192:195], v[136:139], v[224:227]
    v_mfma_f32_16x16x32_bf16 v[228:231], v[192:195], v[140:143], v[228:231]
    v_mfma_f32_16x16x32_bf16 v[228:231], v[196:199], v[136:139], v[228:231]
    s_add_u32 m0, s57, 32768
    s_nop 0
    global_load_lds_dwordx4 v236, s[28:29]
    v_add_u32 v236, 458752, v236
    v_mfma_f32_16x16x32_bf16 v[200:203], v[104:107], v[72:75], v[200:203]
    ds_read2_b32 v[168:169], v12 offset0:128 offset1:129
    v_mfma_f32_16x16x32_bf16 v[204:207], v[104:107], v[76:79], v[204:207]
    ds_read2_b32 v[170:171], v12 offset0:130 offset1:131
    v_mfma_f32_16x16x32_bf16 v[208:211], v[104:107], v[80:83], v[208:211]
    ds_read_b128 v[136:139], v60 offset:0
    v_mfma_f32_16x16x32_bf16 v[212:215], v[104:107], v[84:87], v[212:215]
    ds_read_b128 v[140:143], v60 offset:512
    v_mfma_f32_16x16x32_bf16 v[216:219], v[104:107], v[88:91], v[216:219]
    ds_read_b128 v[144:147], v60 offset:1024
    v_mfma_f32_16x16x32_bf16 v[220:223], v[104:107], v[92:95], v[220:223]
    ds_read_b128 v[148:151], v60 offset:1536
    s_add_u32 m0, s57, 33792
    s_nop 0
    global_load_lds_dwordx4 v237, s[28:29]
    v_add_u32 v237, 458752, v237
    v_mfma_f32_16x16x32_bf16 v[224:227], v[104:107], v[96:99], v[224:227]
    ds_read_b128 v[152:155], v60 offset:2048
    s_waitcnt lgkmcnt(15)
    v_mfma_f32_16x16x32_bf16 v[228:231], v[104:107], v[100:103], v[228:231]
    ds_read_b128 v[156:159], v60 offset:2560
    v_mfma_f32_16x16x32_bf16 v[204:207], v[108:111], v[72:75], v[204:207]
    ds_read_b128 v[160:163], v60 offset:3072
    v_mfma_f32_16x16x32_bf16 v[208:211], v[108:111], v[76:79], v[208:211]
    ds_read_b128 v[164:167], v60 offset:3584
    v_mfma_f32_16x16x32_bf16 v[212:215], v[108:111], v[80:83], v[212:215]
    ds_read2_b32 v[172:173], v12 offset0:0 offset1:1
    v_mfma_f32_16x16x32_bf16 v[216:219], v[108:111], v[84:87], v[216:219]
    ds_read2_b32 v[174:175], v12 offset0:2 offset1:3
    s_add_u32 m0, s57, 34816
    s_nop 0
    global_load_lds_dwordx4 v238, s[28:29]
    v_add_u32 v238, 458752, v238
    v_mfma_f32_16x16x32_bf16 v[220:223], v[108:111], v[88:91], v[220:223]
    ds_read2_b32 v[176:177], v13 offset0:128 offset1:129
    v_mfma_f32_16x16x32_bf16 v[224:227], v[108:111], v[92:95], v[224:227]
    ds_read2_b32 v[178:179], v13 offset0:130 offset1:131
    v_mfma_f32_16x16x32_bf16 v[228:231], v[108:111], v[96:99], v[228:231]
    ds_read2_b32 v[180:181], v13 offset0:0 offset1:1
    v_mfma_f32_16x16x32_bf16 v[208:211], v[112:115], v[72:75], v[208:211]
    ds_read2_b32 v[182:183], v13 offset0:2 offset1:3
    v_mfma_f32_16x16x32_bf16 v[212:215], v[112:115], v[76:79], v[212:215]
    ds_read2_b32 v[184:185], v14 offset0:128 offset1:129
    v_mfma_f32_16x16x32_bf16 v[216:219], v[112:115], v[80:83], v[216:219]
    ds_read2_b32 v[186:187], v14 offset0:130 offset1:131
    s_add_u32 m0, s57, 57344
    s_nop 0
    global_load_lds_dwordx4 v232, s[28:29]
    v_mfma_f32_16x16x32_bf16 v[220:223], v[112:115], v[84:87], v[220:223]
    ds_read2_b32 v[188:189], v14 offset0:0 offset1:1
    v_mfma_f32_16x16x32_bf16 v[224:227], v[112:115], v[88:91], v[224:227]
    ds_read2_b32 v[190:191], v14 offset0:2 offset1:3
    v_mfma_f32_16x16x32_bf16 v[228:231], v[112:115], v[92:95], v[228:231]
    ds_read2_b32 v[192:193], v15 offset0:128 offset1:129
    v_mfma_f32_16x16x32_bf16 v[212:215], v[116:119], v[72:75], v[212:215]
    ds_read2_b32 v[194:195], v15 offset0:130 offset1:131
    v_mfma_f32_16x16x32_bf16 v[216:219], v[116:119], v[76:79], v[216:219]
    ds_read2_b32 v[196:197], v15 offset0:0 offset1:1
    v_mfma_f32_16x16x32_bf16 v[220:223], v[116:119], v[80:83], v[220:223]
    ds_read2_b32 v[198:199], v15 offset0:2 offset1:3
    s_add_u32 m0, s57, 58368
    s_nop 0
    global_load_lds_dwordx4 v233, s[28:29]
    v_mfma_f32_16x16x32_bf16 v[224:227], v[116:119], v[84:87], v[224:227]
    v_subrev_u32 v60, 64, v60
    v_mfma_f32_16x16x32_bf16 v[228:231], v[116:119], v[88:91], v[228:231]
    v_subrev_u32 v12, 64, v12
    s_waitcnt lgkmcnt(15)
    v_mfma_f32_16x16x32_bf16 v[216:219], v[120:123], v[72:75], v[216:219]
    v_subrev_u32 v13, 64, v13
    v_mfma_f32_16x16x32_bf16 v[220:223], v[120:123], v[76:79], v[220:223]
    v_subrev_u32 v14, 64, v14
    v_mfma_f32_16x16x32_bf16 v[224:227], v[120:123], v[80:83], v[224:227]
    v_subrev_u32 v15, 64, v15
    v_mfma_f32_16x16x32_bf16 v[228:231], v[120:123], v[84:87], v[228:231]
    s_add_u32 m0, s57, 59392
    s_nop 0
    global_load_lds_dwordx4 v234, s[28:29]
    v_mfma_f32_16x16x32_bf16 v[220:223], v[124:127], v[72:75], v[220:223]
    v_mfma_f32_16x16x32_bf16 v[224:227], v[124:127], v[76:79], v[224:227]
    v_mfma_f32_16x16x32_bf16 v[228:231], v[124:127], v[80:83], v[228:231]
    v_mfma_f32_16x16x32_bf16 v[224:227], v[128:131], v[72:75], v[224:227]
    v_mfma_f32_16x16x32_bf16 v[228:231], v[128:131], v[76:79], v[228:231]
    v_mfma_f32_16x16x32_bf16 v[228:231], v[132:135], v[72:75], v[228:231]
    s_add_u32 m0, s57, 60416
    s_nop 0
    global_load_lds_dwordx4 v235, s[28:29]
    v_mfma_f32_16x16x32_bf16 v[200:203], v[168:171], v[136:139], v[200:203]
    v_mfma_f32_16x16x32_bf16 v[204:207], v[168:171], v[140:143], v[204:207]
    v_mfma_f32_16x16x32_bf16 v[208:211], v[168:171], v[144:147], v[208:211]
    v_mfma_f32_16x16x32_bf16 v[212:215], v[168:171], v[148:151], v[212:215]
    v_mfma_f32_16x16x32_bf16 v[216:219], v[168:171], v[152:155], v[216:219]
    v_mfma_f32_16x16x32_bf16 v[220:223], v[168:171], v[156:159], v[220:223]
    s_add_u32 m0, s57, 61440
    s_nop 0
    global_load_lds_dwordx4 v236, s[28:29]
    v_mfma_f32_16x16x32_bf16 v[224:227], v[168:171], v[160:163], v[224:227]
    s_waitcnt lgkmcnt(14)
    v_mfma_f32_16x16x32_bf16 v[228:231], v[168:171], v[164:167], v[228:231]
    s_waitcnt lgkmcnt(12)
    v_mfma_f32_16x16x32_bf16 v[204:207], v[172:175], v[136:139], v[204:207]
    v_mfma_f32_16x16x32_bf16 v[208:211], v[172:175], v[140:143], v[208:211]
    v_mfma_f32_16x16x32_bf16 v[212:215], v[172:175], v[144:147], v[212:215]
    v_mfma_f32_16x16x32_bf16 v[216:219], v[172:175], v[148:151], v[216:219]
    s_add_u32 m0, s57, 62464
    s_nop 0
    global_load_lds_dwordx4 v237, s[28:29]
    v_mfma_f32_16x16x32_bf16 v[220:223], v[172:175], v[152:155], v[220:223]
    v_mfma_f32_16x16x32_bf16 v[224:227], v[172:175], v[156:159], v[224:227]
    v_mfma_f32_16x16x32_bf16 v[228:231], v[172:175], v[160:163], v[228:231]
    s_waitcnt lgkmcnt(10)
    v_mfma_f32_16x16x32_bf16 v[208:211], v[176:179], v[136:139], v[208:211]
    v_mfma_f32_16x16x32_bf16 v[212:215], v[176:179], v[140:143], v[212:215]
    v_mfma_f32_16x16x32_bf16 v[216:219], v[176:179], v[144:147], v[216:219]
    s_add_u32 m0, s57, 63488
    s_nop 0
    global_load_lds_dwordx4 v238, s[28:29]
    v_mfma_f32_16x16x32_bf16 v[220:223], v[176:179], v[148:151], v[220:223]
    v_mfma_f32_16x16x32_bf16 v[224:227], v[176:179], v[152:155], v[224:227]
    v_mfma_f32_16x16x32_bf16 v[228:231], v[176:179], v[156:159], v[228:231]
    s_waitcnt lgkmcnt(8)
    v_mfma_f32_16x16x32_bf16 v[212:215], v[180:183], v[136:139], v[212:215]
    v_mfma_f32_16x16x32_bf16 v[216:219], v[180:183], v[140:143], v[216:219]
    v_mfma_f32_16x16x32_bf16 v[220:223], v[180:183], v[144:147], v[220:223]
    v_mfma_f32_16x16x32_bf16 v[224:227], v[180:183], v[148:151], v[224:227]
    v_mfma_f32_16x16x32_bf16 v[228:231], v[180:183], v[152:155], v[228:231]
    s_waitcnt lgkmcnt(6)
    v_mfma_f32_16x16x32_bf16 v[216:219], v[184:187], v[136:139], v[216:219]
    v_mfma_f32_16x16x32_bf16 v[220:223], v[184:187], v[140:143], v[220:223]
    v_mfma_f32_16x16x32_bf16 v[224:227], v[184:187], v[144:147], v[224:227]
    v_mfma_f32_16x16x32_bf16 v[228:231], v[184:187], v[148:151], v[228:231]
    s_waitcnt lgkmcnt(4)
    v_mfma_f32_16x16x32_bf16 v[220:223], v[188:191], v[136:139], v[220:223]
    v_mfma_f32_16x16x32_bf16 v[224:227], v[188:191], v[140:143], v[224:227]
    v_mfma_f32_16x16x32_bf16 v[228:231], v[188:191], v[144:147], v[228:231]
    s_waitcnt lgkmcnt(2)
    v_mfma_f32_16x16x32_bf16 v[224:227], v[192:195], v[136:139], v[224:227]
    v_mfma_f32_16x16x32_bf16 v[228:231], v[192:195], v[140:143], v[228:231]
    s_waitcnt lgkmcnt(0)
    v_mfma_f32_16x16x32_bf16 v[228:231], v[196:199], v[136:139], v[228:231]
    s_lshl_b32 s45, s22, 12
    s_add_u32 s45, s45, 114688
    v_lshlrev_b32 v68, 4, v2
    v_add_u32 v69, s45, v68
    s_xor_b32 s46, s22, 1
    s_lshl_b32 s46, s46, 12
    s_add_u32 s46, s46, 114688
    v_add_u32 v70, s46, v68
    s_cmp_eq_u32 s44, 0
    s_cbranch_scc0 sequential_preLN__ssm_conv_s4__mixer_channel_mlp__prompt_kernel_odd
    ds_write_b128 v69, v[216:219] offset:0
    ds_write_b128 v69, v[220:223] offset:1024
    ds_write_b128 v69, v[224:227] offset:2048
    ds_write_b128 v69, v[228:231] offset:3072
    s_branch sequential_preLN__ssm_conv_s4__mixer_channel_mlp__prompt_kernel_join
sequential_preLN__ssm_conv_s4__mixer_channel_mlp__prompt_kernel_odd:
    ds_write_b128 v69, v[200:203] offset:0
    ds_write_b128 v69, v[204:207] offset:1024
    ds_write_b128 v69, v[208:211] offset:2048
    ds_write_b128 v69, v[212:215] offset:3072
    v_pk_mul_f32 v[200:201], v[216:217], 1.0 op_sel_hi:[1,0]
    v_pk_mul_f32 v[202:203], v[218:219], 1.0 op_sel_hi:[1,0]
    v_pk_mul_f32 v[204:205], v[220:221], 1.0 op_sel_hi:[1,0]
    v_pk_mul_f32 v[206:207], v[222:223], 1.0 op_sel_hi:[1,0]
    v_pk_mul_f32 v[208:209], v[224:225], 1.0 op_sel_hi:[1,0]
    v_pk_mul_f32 v[210:211], v[226:227], 1.0 op_sel_hi:[1,0]
    v_pk_mul_f32 v[212:213], v[228:229], 1.0 op_sel_hi:[1,0]
    v_pk_mul_f32 v[214:215], v[230:231], 1.0 op_sel_hi:[1,0]
sequential_preLN__ssm_conv_s4__mixer_channel_mlp__prompt_kernel_join:
    s_lshl_b32 s45, s44, 11
    s_mul_i32 s46, s42, 4608
    s_add_u32 s46, s46, s45
    s_add_u32 s46, s46, 131552
    v_add_u32 v57, s46, v56
    ds_read_b64 v[88:89], v57 offset:0
    ds_read_b64 v[90:91], v57 offset:512
    ds_read_b64 v[92:93], v57 offset:1024
    ds_read_b64 v[94:95], v57 offset:1536
    s_lshl_b32 s46, s27, 1
    s_add_u32 s46, s46, s42
    s_lshl_b32 s46, s46, 6
    s_lshl_b32 s47, s44, 20
    s_add_u32 s46, s46, s47
    s_add_u32 s46, s46, 5242880
    v_lshrrev_b32 v58, 1, v3
    v_lshlrev_b32 v58, 15, v58
    v_and_b32 v55, 1, v3
    v_lshlrev_b32 v55, 5, v55
    v_lshlrev_b32 v54, 3, v4
    v_add3_u32 v58, v58, v55, v54
    v_add_u32 v58, s46, v58
    s_waitcnt lgkmcnt(0)
    s_barrier
    ds_read_b128 v[72:75], v70 offset:0
    ds_read_b128 v[76:79], v70 offset:1024
    ds_read_b128 v[80:83], v70 offset:2048
    ds_read_b128 v[84:87], v70 offset:3072
    v_lshlrev_b32 v112, 16, v88
    v_and_b32 v113, 0xffff0000, v88
    v_lshlrev_b32 v114, 16, v89
    v_and_b32 v115, 0xffff0000, v89
    v_lshlrev_b32 v116, 16, v90
    v_and_b32 v117, 0xffff0000, v90
    v_lshlrev_b32 v118, 16, v91
    v_and_b32 v119, 0xffff0000, v91
    v_lshlrev_b32 v120, 16, v92
    v_and_b32 v121, 0xffff0000, v92
    v_lshlrev_b32 v122, 16, v93
    v_and_b32 v123, 0xffff0000, v93
    v_lshlrev_b32 v124, 16, v94
    v_and_b32 v125, 0xffff0000, v94
    v_lshlrev_b32 v126, 16, v95
    v_and_b32 v127, 0xffff0000, v95
    v_pk_mul_f32 v[112:113], v[112:113], v[22:23] op_sel:[0,1] op_sel_hi:[1,1]
    v_pk_mul_f32 v[114:115], v[114:115], v[22:23] op_sel:[0,1] op_sel_hi:[1,1]
    v_pk_mul_f32 v[116:117], v[116:117], v[22:23] op_sel:[0,1] op_sel_hi:[1,1]
    v_pk_mul_f32 v[118:119], v[118:119], v[22:23] op_sel:[0,1] op_sel_hi:[1,1]
    v_pk_mul_f32 v[120:121], v[120:121], v[22:23] op_sel:[0,1] op_sel_hi:[1,1]
    v_pk_mul_f32 v[122:123], v[122:123], v[22:23] op_sel:[0,1] op_sel_hi:[1,1]
    v_pk_mul_f32 v[124:125], v[124:125], v[22:23] op_sel:[0,1] op_sel_hi:[1,1]
    v_pk_mul_f32 v[126:127], v[126:127], v[22:23] op_sel:[0,1] op_sel_hi:[1,1]
    v_cvt_pk_bf16_f32 v128, v112, v113
    v_cvt_pk_bf16_f32 v129, v114, v115
    v_cvt_pk_bf16_f32 v130, v116, v117
    v_cvt_pk_bf16_f32 v131, v118, v119
    v_cvt_pk_bf16_f32 v132, v120, v121
    v_cvt_pk_bf16_f32 v133, v122, v123
    v_cvt_pk_bf16_f32 v134, v124, v125
    v_cvt_pk_bf16_f32 v135, v126, v127
    v_lshlrev_b32 v112, 16, v128
    v_and_b32 v113, 0xffff0000, v128
    v_lshlrev_b32 v114, 16, v129
    v_and_b32 v115, 0xffff0000, v129
    v_lshlrev_b32 v116, 16, v130
    v_and_b32 v117, 0xffff0000, v130
    v_lshlrev_b32 v118, 16, v131
    v_and_b32 v119, 0xffff0000, v131
    v_lshlrev_b32 v120, 16, v132
    v_and_b32 v121, 0xffff0000, v132
    v_lshlrev_b32 v122, 16, v133
    v_and_b32 v123, 0xffff0000, v133
    v_lshlrev_b32 v124, 16, v134
    v_and_b32 v125, 0xffff0000, v134
    v_lshlrev_b32 v126, 16, v135
    v_and_b32 v127, 0xffff0000, v135
    s_waitcnt lgkmcnt(0)
    v_pk_add_f32 v[200:201], v[200:201], v[72:73]
    v_pk_add_f32 v[202:203], v[202:203], v[74:75]
    v_pk_add_f32 v[204:205], v[204:205], v[76:77]
    v_pk_add_f32 v[206:207], v[206:207], v[78:79]
    v_pk_add_f32 v[208:209], v[208:209], v[80:81]
    v_pk_add_f32 v[210:211], v[210:211], v[82:83]
    v_pk_add_f32 v[212:213], v[212:213], v[84:85]
    v_pk_add_f32 v[214:215], v[214:215], v[86:87]
    v_cvt_pk_bf16_f32 v128, v200, v201
    v_cvt_pk_bf16_f32 v129, v202, v203
    v_cvt_pk_bf16_f32 v130, v204, v205
    v_cvt_pk_bf16_f32 v131, v206, v207
    v_cvt_pk_bf16_f32 v132, v208, v209
    v_cvt_pk_bf16_f32 v133, v210, v211
    v_cvt_pk_bf16_f32 v134, v212, v213
    v_cvt_pk_bf16_f32 v135, v214, v215
    v_lshlrev_b32 v200, 16, v128
    v_and_b32 v201, 0xffff0000, v128
    v_lshlrev_b32 v202, 16, v129
    v_and_b32 v203, 0xffff0000, v129
    v_lshlrev_b32 v204, 16, v130
    v_and_b32 v205, 0xffff0000, v130
    v_lshlrev_b32 v206, 16, v131
    v_and_b32 v207, 0xffff0000, v131
    v_lshlrev_b32 v208, 16, v132
    v_and_b32 v209, 0xffff0000, v132
    v_lshlrev_b32 v210, 16, v133
    v_and_b32 v211, 0xffff0000, v133
    v_lshlrev_b32 v212, 16, v134
    v_and_b32 v213, 0xffff0000, v134
    v_lshlrev_b32 v214, 16, v135
    v_and_b32 v215, 0xffff0000, v135
    v_pk_add_f32 v[200:201], v[200:201], v[112:113]
    v_pk_add_f32 v[202:203], v[202:203], v[114:115]
    v_pk_add_f32 v[204:205], v[204:205], v[116:117]
    v_pk_add_f32 v[206:207], v[206:207], v[118:119]
    v_pk_add_f32 v[208:209], v[208:209], v[120:121]
    v_pk_add_f32 v[210:211], v[210:211], v[122:123]
    v_pk_add_f32 v[212:213], v[212:213], v[124:125]
    v_pk_add_f32 v[214:215], v[214:215], v[126:127]
    v_cvt_pk_bf16_f32 v128, v200, v201
    v_cvt_pk_bf16_f32 v129, v202, v203
    v_cvt_pk_bf16_f32 v130, v204, v205
    v_cvt_pk_bf16_f32 v131, v206, v207
    v_cvt_pk_bf16_f32 v132, v208, v209
    v_cvt_pk_bf16_f32 v133, v210, v211
    v_cvt_pk_bf16_f32 v134, v212, v213
    v_cvt_pk_bf16_f32 v135, v214, v215
    v_lshlrev_b32 v200, 16, v128
    v_and_b32 v201, 0xffff0000, v128
    v_lshlrev_b32 v202, 16, v129
    v_and_b32 v203, 0xffff0000, v129
    v_lshlrev_b32 v204, 16, v130
    v_and_b32 v205, 0xffff0000, v130
    v_lshlrev_b32 v206, 16, v131
    v_and_b32 v207, 0xffff0000, v131
    v_lshlrev_b32 v208, 16, v132
    v_and_b32 v209, 0xffff0000, v132
    v_lshlrev_b32 v210, 16, v133
    v_and_b32 v211, 0xffff0000, v133
    v_lshlrev_b32 v212, 16, v134
    v_and_b32 v213, 0xffff0000, v134
    v_lshlrev_b32 v214, 16, v135
    v_and_b32 v215, 0xffff0000, v135
    s_waitcnt vmcnt(21)
    v_lshlrev_b32 v112, 16, v240
    v_and_b32 v113, 0xffff0000, v240
    v_lshlrev_b32 v114, 16, v241
    v_and_b32 v115, 0xffff0000, v241
    v_lshlrev_b32 v116, 16, v242
    v_and_b32 v117, 0xffff0000, v242
    v_lshlrev_b32 v118, 16, v243
    v_and_b32 v119, 0xffff0000, v243
    v_lshlrev_b32 v120, 16, v244
    v_and_b32 v121, 0xffff0000, v244
    v_lshlrev_b32 v122, 16, v245
    v_and_b32 v123, 0xffff0000, v245
    v_lshlrev_b32 v124, 16, v246
    v_and_b32 v125, 0xffff0000, v246
    v_lshlrev_b32 v126, 16, v247
    v_and_b32 v127, 0xffff0000, v247
    v_pk_add_f32 v[200:201], v[200:201], v[112:113]
    v_pk_add_f32 v[202:203], v[202:203], v[114:115]
    v_pk_add_f32 v[204:205], v[204:205], v[116:117]
    v_pk_add_f32 v[206:207], v[206:207], v[118:119]
    v_pk_add_f32 v[208:209], v[208:209], v[120:121]
    v_pk_add_f32 v[210:211], v[210:211], v[122:123]
    v_pk_add_f32 v[212:213], v[212:213], v[124:125]
    v_pk_add_f32 v[214:215], v[214:215], v[126:127]
    v_cvt_pk_bf16_f32 v128, v200, v201
    v_cvt_pk_bf16_f32 v129, v202, v203
    ds_write_b64 v57, v[128:129] offset:0
    v_cvt_pk_bf16_f32 v130, v204, v205
    v_cvt_pk_bf16_f32 v131, v206, v207
    ds_write_b64 v57, v[130:131] offset:512
    v_cvt_pk_bf16_f32 v132, v208, v209
    v_cvt_pk_bf16_f32 v133, v210, v211
    ds_write_b64 v57, v[132:133] offset:1024
    v_cvt_pk_bf16_f32 v134, v212, v213
    v_cvt_pk_bf16_f32 v135, v214, v215
    ds_write_b64 v57, v[134:135] offset:1536
    v_lshrrev_b32 v54, 3, v2
    s_lshl_b32 s45, s22, 4
    v_add_u32 v54, s45, v54
    v_bfe_u32 v55, v2, 2, 1
    v_mul_u32_u24 v55, 4608, v55
    v_and_b32 v58, 3, v2
    v_lshlrev_b32 v58, 4, v58
    v_lshlrev_b32 v56, 6, v54
    v_add3_u32 v56, v56, v55, v58
    v_add_u32 v56, 131552, v56
    v_lshlrev_b32 v54, 15, v54
    v_and_b32 v58, 7, v2
    v_lshlrev_b32 v58, 4, v58
    s_lshl_b32 s45, s27, 7
    s_add_u32 s45, s45, 5242880
    v_add3_u32 v58, v54, v58, s45
    v_add_u32 v59, 262144, v58
    s_waitcnt lgkmcnt(0)
    s_barrier
    ds_read_b128 v[128:131], v56
    ds_read_b128 v[132:135], v56 offset:512
    s_waitcnt lgkmcnt(1)
    global_store_dwordx4 v58, v[128:131], s[20:21] sc1
    s_waitcnt lgkmcnt(0)
    global_store_dwordx4 v59, v[132:135], s[20:21] sc1
    s_waitcnt vmcnt(0)
    s_barrier
    s_cmp_eq_u32 s22, 0
    s_cbranch_scc0 sequential_preLN__ssm_conv_s4__mixer_channel_mlp__prompt_kernel_nf2
    s_lshl_b32 s45, s2, 6
    s_add_u32 s45, s45, 65536
    v_mov_b32 v5, s45
    v_mov_b32 v6, s38
    s_mov_b64 s[52:53], exec
    s_mov_b64 exec, 1
    global_store_dword v5, v6, s[20:21] sc1
    s_cmp_eq_u32 s2, 0
    s_cbranch_scc0 sequential_preLN__ssm_conv_s4__mixer_channel_mlp__prompt_kernel_nf2b
    v_mov_b32 v5, 0
    global_store_dword v5, v6, s[20:21] sc1
sequential_preLN__ssm_conv_s4__mixer_channel_mlp__prompt_kernel_nf2b:
    s_mov_b64 exec, s[52:53]
sequential_preLN__ssm_conv_s4__mixer_channel_mlp__prompt_kernel_nf2:
    v_lshlrev_b32 v5, 4, v2
    s_cmp_eq_u32 s22, 0
    s_cbranch_scc0 sequential_preLN__ssm_conv_s4__mixer_channel_mlp__prompt_kernel_np2a
    v_lshlrev_b32 v9, 6, v2
    v_add_u32 v9, 65536, v9
    v_add_u32 v10, 4096, v9
    v_add_u32 v11, 8192, v9
    v_add_u32 v6, 12288, v9
    global_load_dword v176, v9, s[20:21] sc1
    global_load_dword v177, v10, s[20:21] sc1
    global_load_dword v178, v11, s[20:21] sc1
    global_load_dword v179, v6, s[20:21] sc1
sequential_preLN__ssm_conv_s4__mixer_channel_mlp__prompt_kernel_np2a:
    v_add_u32 v252, 0, v8
    v_add_u32 v253, 57344, v8
    v_add_u32 v254, 114688, v8
    v_add_u32 v255, 172032, v8
    s_mov_b32 s65, 0
    v_bfe_u32 v14, v2, 2, 2
    v_lshl_add_u32 v14, v4, 2, v14
    v_mul_u32_u24 v14, 224, v14
    v_and_b32 v15, 3, v2
    v_lshlrev_b32 v15, 3, v15
    v_add_u32 v14, v14, v15
    s_lshl_b32 s45, s22, 6
    s_min_u32 s46, s45, 160
    s_min_u32 s45, s45, 192
    s_add_u32 s46, s46, 32
    v_add_u32 v12, s45, v14
    v_add_u32 v13, s46, v14
    v_add_u32 v16, 57344, v12
    v_add_u32 v17, 57344, v13
    v_mov_b32 v18, 0x3f803f80
    v_mov_b32 v19, 0x3f803f80
    v_mov_b32 v20, 0x3f803f80
    v_mov_b32 v21, 0x3f803f80
    ds_read_b64_tr_b16 v[24:25], v12 offset:0
    ds_read_b64_tr_b16 v[26:27], v12 offset:3584
    ds_read_b64_tr_b16 v[28:29], v13 offset:0
    ds_read_b64_tr_b16 v[30:31], v13 offset:3584
    ds_read_b64_tr_b16 v[32:33], v12 offset:7168
    ds_read_b64_tr_b16 v[34:35], v12 offset:10752
    ds_read_b64_tr_b16 v[36:37], v13 offset:7168
    ds_read_b64_tr_b16 v[38:39], v13 offset:10752
    ds_read_b64_tr_b16 v[40:41], v12 offset:14336
    ds_read_b64_tr_b16 v[42:43], v12 offset:17920
    ds_read_b64_tr_b16 v[44:45], v13 offset:14336
    ds_read_b64_tr_b16 v[46:47], v13 offset:17920
    ds_read_b64_tr_b16 v[48:49], v12 offset:21504
    ds_read_b64_tr_b16 v[50:51], v12 offset:25088
    ds_read_b64_tr_b16 v[52:53], v13 offset:21504
    ds_read_b64_tr_b16 v[54:55], v13 offset:25088
    ds_read_b64_tr_b16 v[56:57], v12 offset:28672
    ds_read_b64_tr_b16 v[58:59], v12 offset:32256
    ds_read_b64_tr_b16 v[60:61], v13 offset:28672
    ds_read_b64_tr_b16 v[62:63], v13 offset:32256
    s_waitcnt lgkmcnt(15)
    v_mfma_f32_16x16x32_bf16 v[140:143], v[24:27], v[18:21], 0
    v_mfma_f32_16x16x32_bf16 v[144:147], v[28:31], v[18:21], 0
    ds_read_b64_tr_b16 v[64:65], v12 offset:35840
    ds_read_b64_tr_b16 v[66:67], v12 offset:39424
    ds_read_b64_tr_b16 v[68:69], v13 offset:35840
    ds_read_b64_tr_b16 v[70:71], v13 offset:39424
    s_waitcnt lgkmcnt(15)
    v_mfma_f32_16x16x32_bf16 v[148:151], v[32:35], v[18:21], 0
    v_mfma_f32_16x16x32_bf16 v[152:155], v[36:39], v[18:21], 0
    ds_read_b64_tr_b16 v[24:25], v12 offset:43008
    ds_read_b64_tr_b16 v[26:27], v12 offset:46592
    ds_read_b64_tr_b16 v[28:29], v13 offset:43008
    ds_read_b64_tr_b16 v[30:31], v13 offset:46592
    s_waitcnt lgkmcnt(15)
    v_mfma_f32_16x16x32_bf16 v[140:143], v[40:43], v[18:21], v[140:143]
    v_mfma_f32_16x16x32_bf16 v[144:147], v[44:47], v[18:21], v[144:147]
    ds_read_b64_tr_b16 v[32:33], v12 offset:50176
    ds_read_b64_tr_b16 v[34:35], v12 offset:53760
    ds_read_b64_tr_b16 v[36:37], v13 offset:50176
    ds_read_b64_tr_b16 v[38:39], v13 offset:53760
    s_waitcnt lgkmcnt(15)
    v_mfma_f32_16x16x32_bf16 v[148:151], v[48:51], v[18:21], v[148:151]
    v_mfma_f32_16x16x32_bf16 v[152:155], v[52:55], v[18:21], v[152:155]
    ds_read_b64_tr_b16 v[40:41], v16 offset:0
    ds_read_b64_tr_b16 v[42:43], v16 offset:3584
    ds_read_b64_tr_b16 v[44:45], v17 offset:0
    ds_read_b64_tr_b16 v[46:47], v17 offset:3584
    s_waitcnt lgkmcnt(15)
    v_mfma_f32_16x16x32_bf16 v[140:143], v[56:59], v[18:21], v[140:143]
    v_mfma_f32_16x16x32_bf16 v[144:147], v[60:63], v[18:21], v[144:147]
    ds_read_b64_tr_b16 v[48:49], v16 offset:7168
    ds_read_b64_tr_b16 v[50:51], v16 offset:10752
    ds_read_b64_tr_b16 v[52:53], v17 offset:7168
    ds_read_b64_tr_b16 v[54:55], v17 offset:10752
    s_waitcnt lgkmcnt(15)
    v_mfma_f32_16x16x32_bf16 v[148:151], v[64:67], v[18:21], v[148:151]
    v_mfma_f32_16x16x32_bf16 v[152:155], v[68:71], v[18:21], v[152:155]
    ds_read_b64_tr_b16 v[56:57], v16 offset:14336
    ds_read_b64_tr_b16 v[58:59], v16 offset:17920
    ds_read_b64_tr_b16 v[60:61], v17 offset:14336
    ds_read_b64_tr_b16 v[62:63], v17 offset:17920
    s_waitcnt lgkmcnt(15)
    v_mfma_f32_16x16x32_bf16 v[140:143], v[24:27], v[18:21], v[140:143]
    v_mfma_f32_16x16x32_bf16 v[144:147], v[28:31], v[18:21], v[144:147]
    ds_read_b64_tr_b16 v[64:65], v16 offset:21504
    ds_read_b64_tr_b16 v[66:67], v16 offset:25088
    ds_read_b64_tr_b16 v[68:69], v17 offset:21504
    ds_read_b64_tr_b16 v[70:71], v17 offset:25088
    s_waitcnt lgkmcnt(15)
    v_mfma_f32_16x16x32_bf16 v[148:151], v[32:35], v[18:21], v[148:151]
    v_mfma_f32_16x16x32_bf16 v[152:155], v[36:39], v[18:21], v[152:155]
    ds_read_b64_tr_b16 v[24:25], v16 offset:28672
    ds_read_b64_tr_b16 v[26:27], v16 offset:32256
    ds_read_b64_tr_b16 v[28:29], v17 offset:28672
    ds_read_b64_tr_b16 v[30:31], v17 offset:32256
    s_waitcnt lgkmcnt(15)
    v_mfma_f32_16x16x32_bf16 v[140:143], v[40:43], v[18:21], v[140:143]
    v_mfma_f32_16x16x32_bf16 v[144:147], v[44:47], v[18:21], v[144:147]
    ds_read_b64_tr_b16 v[32:33], v16 offset:35840
    ds_read_b64_tr_b16 v[34:35], v16 offset:39424
    ds_read_b64_tr_b16 v[36:37], v17 offset:35840
    ds_read_b64_tr_b16 v[38:39], v17 offset:39424
    s_waitcnt lgkmcnt(15)
    v_mfma_f32_16x16x32_bf16 v[148:151], v[48:51], v[18:21], v[148:151]
    v_mfma_f32_16x16x32_bf16 v[152:155], v[52:55], v[18:21], v[152:155]
    ds_read_b64_tr_b16 v[40:41], v16 offset:43008
    ds_read_b64_tr_b16 v[42:43], v16 offset:46592
    ds_read_b64_tr_b16 v[44:45], v17 offset:43008
    ds_read_b64_tr_b16 v[46:47], v17 offset:46592
    s_waitcnt lgkmcnt(15)
    v_mfma_f32_16x16x32_bf16 v[140:143], v[56:59], v[18:21], v[140:143]
    v_mfma_f32_16x16x32_bf16 v[144:147], v[60:63], v[18:21], v[144:147]
    ds_read_b64_tr_b16 v[48:49], v16 offset:50176
    ds_read_b64_tr_b16 v[50:51], v16 offset:53760
    ds_read_b64_tr_b16 v[52:53], v17 offset:50176
    ds_read_b64_tr_b16 v[54:55], v17 offset:53760
    s_waitcnt lgkmcnt(15)
    v_mfma_f32_16x16x32_bf16 v[148:151], v[64:67], v[18:21], v[148:151]
    v_mfma_f32_16x16x32_bf16 v[152:155], v[68:71], v[18:21], v[152:155]
    s_waitcnt lgkmcnt(14)
    v_mfma_f32_16x16x32_bf16 v[140:143], v[24:27], v[18:21], v[140:143]
    s_waitcnt lgkmcnt(12)
    v_mfma_f32_16x16x32_bf16 v[144:147], v[28:31], v[18:21], v[144:147]
    s_waitcnt lgkmcnt(10)
    v_mfma_f32_16x16x32_bf16 v[148:151], v[32:35], v[18:21], v[148:151]
    s_waitcnt lgkmcnt(8)
    v_mfma_f32_16x16x32_bf16 v[152:155], v[36:39], v[18:21], v[152:155]
    s_waitcnt lgkmcnt(6)
    v_mfma_f32_16x16x32_bf16 v[140:143], v[40:43], v[18:21], v[140:143]
    s_waitcnt lgkmcnt(4)
    v_mfma_f32_16x16x32_bf16 v[144:147], v[44:47], v[18:21], v[144:147]
    s_waitcnt lgkmcnt(2)
    v_mfma_f32_16x16x32_bf16 v[148:151], v[48:51], v[18:21], v[148:151]
    s_waitcnt lgkmcnt(0)
    v_mfma_f32_16x16x32_bf16 v[152:155], v[52:55], v[18:21], v[152:155]
    s_nop 5
    v_pk_add_f32 v[140:141], v[140:141], v[148:149]
    v_pk_add_f32 v[142:143], v[142:143], v[150:151]
    v_pk_add_f32 v[144:145], v[144:145], v[152:153]
    v_pk_add_f32 v[146:147], v[146:147], v[154:155]
    s_lshl_b32 s45, s22, 7
    s_add_u32 s45, s45, 114688
    v_lshlrev_b32 v13, 4, v4
    v_add_u32 v13, s45, v13
    v_cmp_eq_u32 vcc, 0, v3
    s_nop 0
    s_and_saveexec_b64 s[52:53], vcc
    ds_write_b128 v13, v[140:143]
    ds_write_b128 v13, v[144:147] offset:64
    s_mov_b64 exec, s[52:53]
    s_mul_i32 s45, s55, 112
    v_lshlrev_b32 v10, 2, v4
    v_add_u32 v10, s45, v10
    v_lshlrev_b32 v10, 1, v10
    global_load_dwordx2 v[228:229], v10, s[30:31] offset:0
    global_load_dwordx2 v[230:231], v10, s[30:31] offset:32
    global_load_dwordx2 v[232:233], v10, s[30:31] offset:64
    global_load_dwordx2 v[234:235], v10, s[30:31] offset:96
    global_load_dwordx2 v[236:237], v10, s[30:31] offset:128
    global_load_dwordx2 v[238:239], v10, s[30:31] offset:160
    global_load_dwordx2 v[240:241], v10, s[30:31] offset:192
    s_waitcnt lgkmcnt(0)
    s_barrier
    v_lshlrev_b32 v13, 4, v4
    v_add_u32 v13, 114688, v13
    ds_read_b128 v[200:203], v13 offset:0
    ds_read_b128 v[204:207], v13 offset:64
    ds_read_b128 v[208:211], v13 offset:128
    ds_read_b128 v[212:215], v13 offset:192
    ds_read_b128 v[216:219], v13 offset:256
    ds_read_b128 v[220:223], v13 offset:320
    ds_read_b128 v[224:227], v13 offset:384
    s_cmp_eq_u32 s22, 0
    s_cbranch_scc0 sequential_preLN__ssm_conv_s4__mixer_channel_mlp__prompt_kernel_np2
    v_lshlrev_b32 v9, 6, v2
    v_add_u32 v9, 65536, v9
    v_add_u32 v10, 4096, v9
    v_add_u32 v11, 8192, v9
    v_add_u32 v12, 12288, v9
    s_mov_b32 s79, 200000
    s_cmp_eq_u32 s65, 1
    s_cbranch_scc1 sequential_preLN__ssm_conv_s4__mixer_channel_mlp__prompt_kernel_p2w
    s_waitcnt vmcnt(7)
    s_branch sequential_preLN__ssm_conv_s4__mixer_channel_mlp__prompt_kernel_p2
sequential_preLN__ssm_conv_s4__mixer_channel_mlp__prompt_kernel_p2w:
    s_waitcnt vmcnt(7)
sequential_preLN__ssm_conv_s4__mixer_channel_mlp__prompt_kernel_p2:
    v_cmp_ne_u32 s[66:67], s38, v176
    v_cmp_ne_u32 s[68:69], s38, v177
    v_cmp_ne_u32 s[70:71], s38, v178
    v_cmp_ne_u32 s[72:73], s38, v179
    s_or_b64 s[52:53], s[66:67], s[68:69]
    s_or_b64 vcc, s[70:71], s[72:73]
    s_or_b64 vcc, vcc, s[52:53]
    s_cmp_eq_u64 vcc, 0
    s_cbranch_scc1 sequential_preLN__ssm_conv_s4__mixer_channel_mlp__prompt_kernel_p2_ok
    s_mov_b64 exec, s[66:67]
    s_cbranch_execz sequential_preLN__ssm_conv_s4__mixer_channel_mlp__prompt_kernel_p2s0
    global_load_dword v176, v9, s[20:21] sc1
sequential_preLN__ssm_conv_s4__mixer_channel_mlp__prompt_kernel_p2s0:
    s_mov_b64 exec, s[68:69]
    s_cbranch_execz sequential_preLN__ssm_conv_s4__mixer_channel_mlp__prompt_kernel_p2s1
    global_load_dword v177, v10, s[20:21] sc1
sequential_preLN__ssm_conv_s4__mixer_channel_mlp__prompt_kernel_p2s1:
    s_mov_b64 exec, s[70:71]
    s_cbranch_execz sequential_preLN__ssm_conv_s4__mixer_channel_mlp__prompt_kernel_p2s2
    global_load_dword v178, v11, s[20:21] sc1
sequential_preLN__ssm_conv_s4__mixer_channel_mlp__prompt_kernel_p2s2:
    s_mov_b64 exec, s[72:73]
    s_cbranch_execz sequential_preLN__ssm_conv_s4__mixer_channel_mlp__prompt_kernel_p2s3
    global_load_dword v179, v12, s[20:21] sc1
sequential_preLN__ssm_conv_s4__mixer_channel_mlp__prompt_kernel_p2s3:
    s_mov_b64 exec, -1
    s_waitcnt vmcnt(0)
    s_sub_u32 s79, s79, 1
    s_cmp_eq_u32 s79, 0
    s_cbranch_scc0 sequential_preLN__ssm_conv_s4__mixer_channel_mlp__prompt_kernel_p2
sequential_preLN__ssm_conv_s4__mixer_channel_mlp__prompt_kernel_p2_ok:
sequential_preLN__ssm_conv_s4__mixer_channel_mlp__prompt_kernel_np2:
    s_waitcnt lgkmcnt(0)
    s_barrier
    s_and_b32 s54, s26, 1
    s_lshl_b32 s45, s23, 1
    s_add_u32 s54, s54, s45
    v_lshrrev_b32 v7, 2, v2
    v_lshlrev_b32 v7, 6, v7
    v_and_b32 v10, 3, v2
    v_bfe_u32 v9, v2, 4, 1
    v_lshlrev_b32 v9, 1, v9
    v_xor_b32 v10, v10, v9
    v_lshlrev_b32 v10, 4, v10
    s_lshl_b32 s45, s54, 2
    s_add_u32 s45, s45, s22
    s_lshl_b32 s45, s45, 15
    s_add_u32 s45, s45, 5242880
    v_add3_u32 v7, v7, v10, s45
    s_mul_i32 s58, s22, 12288
    s_add_u32 s58, s58, 114688
    s_cmp_eq_u32 s22, 0
    s_cbranch_scc0 sequential_preLN__ssm_conv_s4__mixer_channel_mlp__prompt_kernel_nwarmh
    s_lshl_b32 s45, s23, 18
    s_lshl_b32 s46, s26, 13
    s_add_u32 s45, s45, s46
    s_add_u32 s45, s45, 5242880
    v_lshlrev_b32 v9, 7, v2
    v_add_u32 v9, s45, v9
    global_load_dword v250, v9, s[20:21] sc1
sequential_preLN__ssm_conv_s4__mixer_channel_mlp__prompt_kernel_nwarmh:
    s_lshr_b32 s45, s55, 1
    s_add_u32 s66, s45, 0
    s_and_b32 s66, s66, 7
    s_add_u32 s67, s45, 1
    s_and_b32 s67, s67, 7
    s_add_u32 s68, s45, 2
    s_and_b32 s68, s68, 7
    s_add_u32 s69, s45, 3
    s_and_b32 s69, s69, 7
    s_add_u32 s70, s45, 4
    s_and_b32 s70, s70, 7
    s_add_u32 s71, s45, 5
    s_and_b32 s71, s71, 7
    s_add_u32 s72, s45, 6
    s_and_b32 s72, s72, 7
    s_add_u32 s73, s45, 7
    s_and_b32 s73, s73, 7
    s_add_u32 m0, s58, 0
    s_lshl_b32 s45, s66, 12
    v_add_u32 v10, s45, v7
    global_load_lds_dwordx4 v10, s[20:21] sc1
    global_load_lds_dwordx4 v10, s[20:21] offset:1024 sc1
    global_load_lds_dwordx4 v10, s[20:21] offset:2048 sc1
    global_load_lds_dwordx4 v10, s[20:21] offset:3072 sc1
    s_add_u32 m0, s58, 4096
    s_lshl_b32 s45, s67, 12
    v_add_u32 v10, s45, v7
    global_load_lds_dwordx4 v10, s[20:21] sc1
    global_load_lds_dwordx4 v10, s[20:21] offset:1024 sc1
    global_load_lds_dwordx4 v10, s[20:21] offset:2048 sc1
    global_load_lds_dwordx4 v10, s[20:21] offset:3072 sc1
    s_add_u32 m0, s58, 8192
    s_lshl_b32 s45, s68, 12
    v_add_u32 v10, s45, v7
    global_load_lds_dwordx4 v10, s[20:21] sc1
    global_load_lds_dwordx4 v10, s[20:21] offset:1024 sc1
    global_load_lds_dwordx4 v10, s[20:21] offset:2048 sc1
    global_load_lds_dwordx4 v10, s[20:21] offset:3072 sc1
    v_add_u32 v252, 0, v8
    v_add_u32 v253, 57344, v8
    v_add_u32 v254, 114688, v8
    v_add_u32 v255, 172032, v8
    v_bfe_u32 v14, v2, 2, 2
    v_lshl_add_u32 v14, v4, 2, v14
    v_and_b32 v15, 3, v2
    v_lshlrev_b32 v15, 3, v15
    v_mul_u32_u24 v11, 224, v14
    v_add_u32 v11, v11, v15
    s_mul_i32 s45, s66, 14336
    v_add_u32 v12, s45, v11
    v_lshlrev_b32 v14, 6, v14
    v_add3_u32 v14, v14, v15, s58
    v_and_b32 v15, 1, v4
    v_lshlrev_b32 v15, 5, v15
    v_add_u32 v16, v14, v15
    v_xor_b32 v15, 32, v15
    v_add_u32 v17, v14, v15
    s_lshl_b32 s45, s54, 15
    s_lshl_b32 s46, s22, 9
    s_add_u32 s45, s45, s46
    s_add_u32 s45, s45, 131072
    v_lshlrev_b32 v246, 4, v2
    s_lshl_b32 s46, s55, 11
    s_add_u32 s46, s46, s45
    v_add_u32 v247, s46, v246
    v_lshlrev_b32 v248, 4, v3
    v_lshlrev_b32 v249, 13, v4
    v_add3_u32 v248, v248, v249, s45
    v_cmp_eq_u32 s[76:77], 1, v4
    s_and_b32 s46, s55, 1
    s_cmp_eq_u32 s46, 1
    s_cselect_b64 s[74:75], -1, 0
    v_lshl_add_u32 v24, v4, 2, 0
    v_cmp_eq_u32 vcc, v24, v3
    s_nop 1
    v_cndmask_b32 v242, 0, 1.0, vcc
    v_lshl_add_u32 v24, v4, 2, 1
    v_cmp_eq_u32 vcc, v24, v3
    s_nop 1
    v_cndmask_b32 v243, 0, 1.0, vcc
    v_lshl_add_u32 v24, v4, 2, 2
    v_cmp_eq_u32 vcc, v24, v3
    s_nop 1
    v_cndmask_b32 v244, 0, 1.0, vcc
    v_lshl_add_u32 v24, v4, 2, 3
    v_cmp_eq_u32 vcc, v24, v3
    s_nop 1
    v_cndmask_b32 v245, 0, 1.0, vcc
    s_mul_i32 s45, s23, 917504
    s_mul_i32 s46, s26, 28672
    s_add_u32 s45, s45, s46
    s_mul_i32 s46, s22, 7168
    s_add_u32 s45, s45, s46
    s_add_u32 s45, s45, 11534336
    v_min_u32 v6, 55, v2
    v_lshlrev_b32 v6, 7, v6
    v_add_u32 v6, s45, v6
    s_waitcnt vmcnt(8)
    ds_read_b64_tr_b16 v[52:53], v16 offset:0
    ds_read_b64_tr_b16 v[54:55], v16 offset:1024
    ds_read_b64_tr_b16 v[24:25], v12 offset:0
    ds_read_b64_tr_b16 v[26:27], v12 offset:3584
    ds_read_b64_tr_b16 v[28:29], v12 offset:32
    ds_read_b64_tr_b16 v[30:31], v12 offset:3616
    ds_read_b64_tr_b16 v[32:33], v12 offset:64
    ds_read_b64_tr_b16 v[34:35], v12 offset:3648
    ds_read_b64_tr_b16 v[36:37], v12 offset:96
    ds_read_b64_tr_b16 v[38:39], v12 offset:3680
    ds_read_b64_tr_b16 v[40:41], v12 offset:128
    ds_read_b64_tr_b16 v[42:43], v12 offset:3712
    ds_read_b64_tr_b16 v[44:45], v12 offset:160
    ds_read_b64_tr_b16 v[46:47], v12 offset:3744
    ds_read_b64_tr_b16 v[48:49], v12 offset:192
    ds_read_b64_tr_b16 v[50:51], v12 offset:3776
    ds_read_b64_tr_b16 v[56:57], v17 offset:0
    ds_read_b64_tr_b16 v[58:59], v17 offset:1024
    s_mul_i32 s45, s67, 14336
    v_add_u32 v13, s45, v11
    s_waitcnt lgkmcnt(14)
    v_mfma_f32_16x16x32_bf16 v[96:99], v[24:27], v[52:55], 0
    ds_read_b64_tr_b16 v[88:89], v16 offset:2048
    ds_read_b64_tr_b16 v[90:91], v16 offset:3072
    s_waitcnt lgkmcnt(14)
    v_mfma_f32_16x16x32_bf16 v[104:107], v[28:31], v[52:55], 0
    ds_read_b64_tr_b16 v[60:61], v12 offset:7168
    s_waitcnt lgkmcnt(13)
    v_mfma_f32_16x16x32_bf16 v[112:115], v[32:35], v[52:55], 0
    ds_read_b64_tr_b16 v[62:63], v12 offset:10752
    s_waitcnt lgkmcnt(12)
    v_mfma_f32_16x16x32_bf16 v[120:123], v[36:39], v[52:55], 0
    ds_read_b64_tr_b16 v[64:65], v12 offset:7200
    s_waitcnt lgkmcnt(11)
    v_mfma_f32_16x16x32_bf16 v[128:131], v[40:43], v[52:55], 0
    ds_read_b64_tr_b16 v[66:67], v12 offset:10784
    s_waitcnt lgkmcnt(10)
    v_mfma_f32_16x16x32_bf16 v[136:139], v[44:47], v[52:55], 0
    ds_read_b64_tr_b16 v[68:69], v12 offset:7232
    s_waitcnt lgkmcnt(9)
    v_mfma_f32_16x16x32_bf16 v[144:147], v[48:51], v[52:55], 0
    ds_read_b64_tr_b16 v[70:71], v12 offset:10816
    v_mfma_f32_16x16x32_bf16 v[152:155], v[18:21], v[52:55], 0
    ds_read_b64_tr_b16 v[72:73], v12 offset:7264
    v_mfma_f32_16x16x32_bf16 v[160:163], v[52:55], v[52:55], 0
    ds_read_b64_tr_b16 v[74:75], v12 offset:10848
    s_waitcnt lgkmcnt(10)
    v_mfma_f32_16x16x32_bf16 v[100:103], v[24:27], v[56:59], 0
    ds_read_b64_tr_b16 v[76:77], v12 offset:7296
    v_mfma_f32_16x16x32_bf16 v[108:111], v[28:31], v[56:59], 0
    ds_read_b64_tr_b16 v[78:79], v12 offset:10880
    v_mfma_f32_16x16x32_bf16 v[116:119], v[32:35], v[56:59], 0
    ds_read_b64_tr_b16 v[80:81], v12 offset:7328
    v_mfma_f32_16x16x32_bf16 v[124:127], v[36:39], v[56:59], 0
    ds_read_b64_tr_b16 v[82:83], v12 offset:10912
    v_mfma_f32_16x16x32_bf16 v[132:135], v[40:43], v[56:59], 0
    ds_read_b64_tr_b16 v[84:85], v12 offset:7360
    v_mfma_f32_16x16x32_bf16 v[140:143], v[44:47], v[56:59], 0
    ds_read_b64_tr_b16 v[86:87], v12 offset:10944
    v_mfma_f32_16x16x32_bf16 v[148:151], v[48:51], v[56:59], 0
    ds_read_b64_tr_b16 v[92:93], v17 offset:2048
    v_mfma_f32_16x16x32_bf16 v[156:159], v[18:21], v[56:59], 0
    ds_read_b64_tr_b16 v[94:95], v17 offset:3072
    v_mfma_f32_16x16x32_bf16 v[164:167], v[56:59], v[56:59], 0
    s_waitcnt vmcnt(4)
    s_waitcnt lgkmcnt(14)
    v_mfma_f32_16x16x32_bf16 v[96:99], v[60:63], v[88:91], v[96:99]
    ds_read_b64_tr_b16 v[52:53], v16 offset:4096
    ds_read_b64_tr_b16 v[54:55], v16 offset:5120
    s_waitcnt lgkmcnt(14)
    v_mfma_f32_16x16x32_bf16 v[104:107], v[64:67], v[88:91], v[104:107]
    ds_read_b64_tr_b16 v[24:25], v13 offset:0
    s_waitcnt lgkmcnt(13)
    v_mfma_f32_16x16x32_bf16 v[112:115], v[68:71], v[88:91], v[112:115]
    ds_read_b64_tr_b16 v[26:27], v13 offset:3584
    s_waitcnt lgkmcnt(12)
    v_mfma_f32_16x16x32_bf16 v[120:123], v[72:75], v[88:91], v[120:123]
    ds_read_b64_tr_b16 v[28:29], v13 offset:32
    s_waitcnt lgkmcnt(11)
    v_mfma_f32_16x16x32_bf16 v[128:131], v[76:79], v[88:91], v[128:131]
    ds_read_b64_tr_b16 v[30:31], v13 offset:3616
    global_load_dwordx4 a[0:3], v252, s[20:21] offset:0 sc1
    s_waitcnt lgkmcnt(10)
    v_mfma_f32_16x16x32_bf16 v[136:139], v[80:83], v[88:91], v[136:139]
    ds_read_b64_tr_b16 v[32:33], v13 offset:64
    s_waitcnt lgkmcnt(9)
    v_mfma_f32_16x16x32_bf16 v[144:147], v[84:87], v[88:91], v[144:147]
    ds_read_b64_tr_b16 v[34:35], v13 offset:3648
    v_mfma_f32_16x16x32_bf16 v[168:171], v[18:21], v[88:91], 0
    ds_read_b64_tr_b16 v[36:37], v13 offset:96
    v_mfma_f32_16x16x32_bf16 v[176:179], v[88:91], v[88:91], 0
    ds_read_b64_tr_b16 v[38:39], v13 offset:3680
    global_load_dwordx4 a[4:7], v253, s[20:21] offset:0 sc1
    s_waitcnt lgkmcnt(10)
    v_mfma_f32_16x16x32_bf16 v[100:103], v[60:63], v[92:95], v[100:103]
    ds_read_b64_tr_b16 v[40:41], v13 offset:128
    v_mfma_f32_16x16x32_bf16 v[108:111], v[64:67], v[92:95], v[108:111]
    ds_read_b64_tr_b16 v[42:43], v13 offset:3712
    v_mfma_f32_16x16x32_bf16 v[116:119], v[68:71], v[92:95], v[116:119]
    ds_read_b64_tr_b16 v[44:45], v13 offset:160
    v_mfma_f32_16x16x32_bf16 v[124:127], v[72:75], v[92:95], v[124:127]
    ds_read_b64_tr_b16 v[46:47], v13 offset:3744
    global_load_dwordx4 a[8:11], v254, s[20:21] offset:0 sc1
    v_mfma_f32_16x16x32_bf16 v[132:135], v[76:79], v[92:95], v[132:135]
    ds_read_b64_tr_b16 v[48:49], v13 offset:192
    v_mfma_f32_16x16x32_bf16 v[140:143], v[80:83], v[92:95], v[140:143]
    ds_read_b64_tr_b16 v[50:51], v13 offset:3776
    v_mfma_f32_16x16x32_bf16 v[148:151], v[84:87], v[92:95], v[148:151]
    ds_read_b64_tr_b16 v[56:57], v17 offset:4096
    v_mfma_f32_16x16x32_bf16 v[172:175], v[18:21], v[92:95], 0
    ds_read_b64_tr_b16 v[58:59], v17 offset:5120
    v_mfma_f32_16x16x32_bf16 v[180:183], v[92:95], v[92:95], 0
    s_mul_i32 s45, s68, 14336
    v_add_u32 v12, s45, v11
    s_waitcnt lgkmcnt(14)
    v_mfma_f32_16x16x32_bf16 v[96:99], v[24:27], v[52:55], v[96:99]
    ds_read_b64_tr_b16 v[88:89], v16 offset:6144
    ds_read_b64_tr_b16 v[90:91], v16 offset:7168
    s_add_u32 m0, s58, 0
    s_lshl_b32 s45, s69, 12
    v_add_u32 v10, s45, v7
    global_load_lds_dwordx4 v10, s[20:21] sc1
    global_load_lds_dwordx4 v10, s[20:21] offset:1024 sc1
    global_load_lds_dwordx4 v10, s[20:21] offset:2048 sc1
    global_load_lds_dwordx4 v10, s[20:21] offset:3072 sc1
    s_waitcnt lgkmcnt(14)
    v_mfma_f32_16x16x32_bf16 v[104:107], v[28:31], v[52:55], v[104:107]
    ds_read_b64_tr_b16 v[60:61], v13 offset:7168
    s_waitcnt lgkmcnt(13)
    v_mfma_f32_16x16x32_bf16 v[112:115], v[32:35], v[52:55], v[112:115]
    ds_read_b64_tr_b16 v[62:63], v13 offset:10752
    s_waitcnt lgkmcnt(12)
    v_mfma_f32_16x16x32_bf16 v[120:123], v[36:39], v[52:55], v[120:123]
    ds_read_b64_tr_b16 v[64:65], v13 offset:7200
    ds_read_b64_tr_b16 v[66:67], v13 offset:10784
    s_waitcnt lgkmcnt(12)
    v_mfma_f32_16x16x32_bf16 v[128:131], v[40:43], v[52:55], v[128:131]
    ds_read_b64_tr_b16 v[68:69], v13 offset:7232
    global_load_dwordx4 a[12:15], v255, s[20:21] offset:0 sc1
    s_waitcnt lgkmcnt(11)
    v_mfma_f32_16x16x32_bf16 v[136:139], v[44:47], v[52:55], v[136:139]
    ds_read_b64_tr_b16 v[70:71], v13 offset:10816
    s_waitcnt lgkmcnt(10)
    v_mfma_f32_16x16x32_bf16 v[144:147], v[48:51], v[52:55], v[144:147]
    ds_read_b64_tr_b16 v[72:73], v13 offset:7264
    ds_read_b64_tr_b16 v[74:75], v13 offset:10848
    s_waitcnt lgkmcnt(10)
    v_mfma_f32_16x16x32_bf16 v[100:103], v[24:27], v[56:59], v[100:103]
    ds_read_b64_tr_b16 v[76:77], v13 offset:7296
    v_mfma_f32_16x16x32_bf16 v[108:111], v[28:31], v[56:59], v[108:111]
    ds_read_b64_tr_b16 v[78:79], v13 offset:10880
    global_load_dwordx4 a[16:19], v252, s[20:21] offset:1024 sc1
    v_mfma_f32_16x16x32_bf16 v[116:119], v[32:35], v[56:59], v[116:119]
    ds_read_b64_tr_b16 v[80:81], v13 offset:7328
    ds_read_b64_tr_b16 v[82:83], v13 offset:10912
    v_mfma_f32_16x16x32_bf16 v[124:127], v[36:39], v[56:59], v[124:127]
    ds_read_b64_tr_b16 v[84:85], v13 offset:7360
    v_mfma_f32_16x16x32_bf16 v[132:135], v[40:43], v[56:59], v[132:135]
    ds_read_b64_tr_b16 v[86:87], v13 offset:10944
    v_mfma_f32_16x16x32_bf16 v[140:143], v[44:47], v[56:59], v[140:143]
    ds_read_b64_tr_b16 v[92:93], v17 offset:6144
    ds_read_b64_tr_b16 v[94:95], v17 offset:7168
    global_load_dwordx4 a[20:23], v253, s[20:21] offset:1024 sc1
    v_mfma_f32_16x16x32_bf16 v[148:151], v[48:51], v[56:59], v[148:151]
    s_waitcnt vmcnt(10)
    s_waitcnt lgkmcnt(14)
    v_mfma_f32_16x16x32_bf16 v[96:99], v[60:63], v[88:91], v[96:99]
    ds_read_b64_tr_b16 v[52:53], v16 offset:8192
    ds_read_b64_tr_b16 v[54:55], v16 offset:9216
    s_waitcnt lgkmcnt(14)
    v_mfma_f32_16x16x32_bf16 v[104:107], v[64:67], v[88:91], v[104:107]
    ds_read_b64_tr_b16 v[24:25], v12 offset:0
    v_cndmask_b32_e64 v184, v152, v168, s[74:75]
    s_waitcnt lgkmcnt(13)
    v_mfma_f32_16x16x32_bf16 v[112:115], v[68:71], v[88:91], v[112:115]
    ds_read_b64_tr_b16 v[26:27], v12 offset:3584
    s_waitcnt lgkmcnt(12)
    v_mfma_f32_16x16x32_bf16 v[120:123], v[72:75], v[88:91], v[120:123]
    ds_read_b64_tr_b16 v[28:29], v12 offset:32
    ds_read_b64_tr_b16 v[30:31], v12 offset:3616
    v_cndmask_b32_e64 v160, v160, v176, s[74:75]
    s_waitcnt lgkmcnt(12)
    v_mfma_f32_16x16x32_bf16 v[128:131], v[76:79], v[88:91], v[128:131]
    ds_read_b64_tr_b16 v[32:33], v12 offset:64
    global_load_dwordx4 a[24:27], v254, s[20:21] offset:1024 sc1
    s_waitcnt lgkmcnt(11)
    v_mfma_f32_16x16x32_bf16 v[136:139], v[80:83], v[88:91], v[136:139]
    ds_read_b64_tr_b16 v[34:35], v12 offset:3648
    v_cndmask_b32_e64 v161, v161, v177, s[74:75]
    s_waitcnt lgkmcnt(10)
    v_mfma_f32_16x16x32_bf16 v[144:147], v[84:87], v[88:91], v[144:147]
    ds_read_b64_tr_b16 v[36:37], v12 offset:96
    ds_read_b64_tr_b16 v[38:39], v12 offset:3680
    s_waitcnt lgkmcnt(10)
    v_mfma_f32_16x16x32_bf16 v[100:103], v[60:63], v[92:95], v[100:103]
    ds_read_b64_tr_b16 v[40:41], v12 offset:128
    v_cndmask_b32_e64 v162, v162, v178, s[74:75]
    v_mfma_f32_16x16x32_bf16 v[108:111], v[64:67], v[92:95], v[108:111]
    ds_read_b64_tr_b16 v[42:43], v12 offset:3712
    global_load_dwordx4 a[28:31], v255, s[20:21] offset:1024 sc1
    v_mfma_f32_16x16x32_bf16 v[116:119], v[68:71], v[92:95], v[116:119]
    ds_read_b64_tr_b16 v[44:45], v12 offset:160
    ds_read_b64_tr_b16 v[46:47], v12 offset:3744
    v_cndmask_b32_e64 v163, v163, v179, s[74:75]
    v_mfma_f32_16x16x32_bf16 v[124:127], v[72:75], v[92:95], v[124:127]
    ds_read_b64_tr_b16 v[48:49], v12 offset:192
    v_mfma_f32_16x16x32_bf16 v[132:135], v[76:79], v[92:95], v[132:135]
    ds_read_b64_tr_b16 v[50:51], v12 offset:3776
    v_cndmask_b32_e64 v188, v156, v172, s[74:75]
    v_mfma_f32_16x16x32_bf16 v[140:143], v[80:83], v[92:95], v[140:143]
    ds_read_b64_tr_b16 v[56:57], v17 offset:8192
    ds_read_b64_tr_b16 v[58:59], v17 offset:9216
    global_load_dwordx4 a[32:35], v252, s[20:21] offset:2048 sc1
    v_mfma_f32_16x16x32_bf16 v[148:151], v[84:87], v[92:95], v[148:151]
    v_cndmask_b32_e64 v164, v164, v180, s[74:75]
    s_mul_i32 s45, s69, 14336
    v_add_u32 v13, s45, v11
    s_waitcnt lgkmcnt(14)
    v_mfma_f32_16x16x32_bf16 v[96:99], v[24:27], v[52:55], v[96:99]
    ds_read_b64_tr_b16 v[88:89], v16 offset:10240
    ds_read_b64_tr_b16 v[90:91], v16 offset:11264
    s_add_u32 m0, s58, 4096
    s_lshl_b32 s45, s70, 12
    v_add_u32 v10, s45, v7
    global_load_lds_dwordx4 v10, s[20:21] sc1
    global_load_lds_dwordx4 v10, s[20:21] offset:1024 sc1
    global_load_lds_dwordx4 v10, s[20:21] offset:2048 sc1
    global_load_lds_dwordx4 v10, s[20:21] offset:3072 sc1
    s_waitcnt lgkmcnt(14)
    v_mfma_f32_16x16x32_bf16 v[104:107], v[28:31], v[52:55], v[104:107]
    ds_read_b64_tr_b16 v[60:61], v12 offset:7168
    v_cndmask_b32_e64 v165, v165, v181, s[74:75]
    s_waitcnt lgkmcnt(13)
    v_mfma_f32_16x16x32_bf16 v[112:115], v[32:35], v[52:55], v[112:115]
    ds_read_b64_tr_b16 v[62:63], v12 offset:10752
    s_waitcnt lgkmcnt(12)
    v_mfma_f32_16x16x32_bf16 v[120:123], v[36:39], v[52:55], v[120:123]
    ds_read_b64_tr_b16 v[64:65], v12 offset:7200
    ds_read_b64_tr_b16 v[66:67], v12 offset:10784
    v_cndmask_b32_e64 v166, v166, v182, s[74:75]
    s_waitcnt lgkmcnt(12)
    v_mfma_f32_16x16x32_bf16 v[128:131], v[40:43], v[52:55], v[128:131]
    ds_read_b64_tr_b16 v[68:69], v12 offset:7232
    global_load_dwordx4 a[36:39], v253, s[20:21] offset:2048 sc1
    s_waitcnt lgkmcnt(11)
    v_mfma_f32_16x16x32_bf16 v[136:139], v[44:47], v[52:55], v[136:139]
    ds_read_b64_tr_b16 v[70:71], v12 offset:10816
    v_cndmask_b32_e64 v167, v167, v183, s[74:75]
    s_waitcnt lgkmcnt(10)
    v_mfma_f32_16x16x32_bf16 v[144:147], v[48:51], v[52:55], v[144:147]
    ds_read_b64_tr_b16 v[72:73], v12 offset:7264
    ds_read_b64_tr_b16 v[74:75], v12 offset:10848
    s_waitcnt lgkmcnt(10)
    v_mfma_f32_16x16x32_bf16 v[100:103], v[24:27], v[56:59], v[100:103]
    ds_read_b64_tr_b16 v[76:77], v12 offset:7296
    v_mul_f32 v186, v160, v242
    v_mfma_f32_16x16x32_bf16 v[108:111], v[28:31], v[56:59], v[108:111]
    ds_read_b64_tr_b16 v[78:79], v12 offset:10880
    global_load_dwordx4 a[40:43], v254, s[20:21] offset:2048 sc1
    v_mfma_f32_16x16x32_bf16 v[116:119], v[32:35], v[56:59], v[116:119]
    ds_read_b64_tr_b16 v[80:81], v12 offset:7328
    ds_read_b64_tr_b16 v[82:83], v12 offset:10912
    v_fmac_f32 v186, v161, v243
    v_mfma_f32_16x16x32_bf16 v[124:127], v[36:39], v[56:59], v[124:127]
    ds_read_b64_tr_b16 v[84:85], v12 offset:7360
    v_mfma_f32_16x16x32_bf16 v[132:135], v[40:43], v[56:59], v[132:135]
    ds_read_b64_tr_b16 v[86:87], v12 offset:10944
    v_fmac_f32 v186, v162, v244
    v_mfma_f32_16x16x32_bf16 v[140:143], v[44:47], v[56:59], v[140:143]
    ds_read_b64_tr_b16 v[92:93], v17 offset:10240
    ds_read_b64_tr_b16 v[94:95], v17 offset:11264
    global_load_dwordx4 a[44:47], v255, s[20:21] offset:2048 sc1
    v_mfma_f32_16x16x32_bf16 v[148:151], v[48:51], v[56:59], v[148:151]
    v_fmac_f32 v186, v163, v245
    v_mul_f32 v190, v164, v242
    v_fmac_f32 v190, v165, v243
    v_fmac_f32 v190, v166, v244
    v_fmac_f32 v190, v167, v245
    v_mov_b32 v192, v186
    v_mov_b32 v193, v190
    s_nop 0
    v_permlane16_swap_b32 v186, v192
    v_permlane16_swap_b32 v190, v193
    v_add_f32 v186, v186, v192
    v_add_f32 v190, v190, v193
    v_mov_b32 v192, v186
    v_mov_b32 v193, v190
    s_nop 0
    v_permlane32_swap_b32 v186, v192
    v_permlane32_swap_b32 v190, v193
    v_add_f32 v186, v186, v192
    v_add_f32 v190, v190, v193
    v_mov_b32 v185, s38
    v_mov_b32 v187, s38
    v_mov_b32 v189, s38
    v_mov_b32 v191, s38
    v_cndmask_b32_e64 v184, v184, v188, s[76:77]
    v_cndmask_b32_e64 v186, v186, v190, s[76:77]
    s_mov_b32 exec_hi, 0
    global_store_dwordx4 v247, v[184:187], s[20:21] sc1
    s_mov_b32 exec_hi, -1
    s_waitcnt vmcnt(14)
    s_waitcnt lgkmcnt(14)
    v_mfma_f32_16x16x32_bf16 v[96:99], v[60:63], v[88:91], v[96:99]
    ds_read_b64_tr_b16 v[52:53], v16 offset:0
    ds_read_b64_tr_b16 v[54:55], v16 offset:1024
    s_waitcnt lgkmcnt(14)
    v_mfma_f32_16x16x32_bf16 v[104:107], v[64:67], v[88:91], v[104:107]
    ds_read_b64_tr_b16 v[24:25], v13 offset:0
    s_waitcnt lgkmcnt(13)
    v_mfma_f32_16x16x32_bf16 v[112:115], v[68:71], v[88:91], v[112:115]
    ds_read_b64_tr_b16 v[26:27], v13 offset:3584
    s_waitcnt lgkmcnt(12)
    v_mfma_f32_16x16x32_bf16 v[120:123], v[72:75], v[88:91], v[120:123]
    ds_read_b64_tr_b16 v[28:29], v13 offset:32
    ds_read_b64_tr_b16 v[30:31], v13 offset:3616
    s_waitcnt lgkmcnt(12)
    v_mfma_f32_16x16x32_bf16 v[128:131], v[76:79], v[88:91], v[128:131]
    ds_read_b64_tr_b16 v[32:33], v13 offset:64
    global_load_dwordx4 a[48:51], v252, s[20:21] offset:3072 sc1
    v_add_u32 v252, 4096, v252
    s_waitcnt lgkmcnt(11)
    v_mfma_f32_16x16x32_bf16 v[136:139], v[80:83], v[88:91], v[136:139]
    ds_read_b64_tr_b16 v[34:35], v13 offset:3648
    s_waitcnt lgkmcnt(10)
    v_mfma_f32_16x16x32_bf16 v[144:147], v[84:87], v[88:91], v[144:147]
    ds_read_b64_tr_b16 v[36:37], v13 offset:96
    ds_read_b64_tr_b16 v[38:39], v13 offset:3680
    s_waitcnt lgkmcnt(10)
    v_mfma_f32_16x16x32_bf16 v[100:103], v[60:63], v[92:95], v[100:103]
    ds_read_b64_tr_b16 v[40:41], v13 offset:128
    v_mfma_f32_16x16x32_bf16 v[108:111], v[64:67], v[92:95], v[108:111]
    ds_read_b64_tr_b16 v[42:43], v13 offset:3712
    global_load_dwordx4 a[52:55], v253, s[20:21] offset:3072 sc1
    v_add_u32 v253, 4096, v253
    v_mfma_f32_16x16x32_bf16 v[116:119], v[68:71], v[92:95], v[116:119]
    ds_read_b64_tr_b16 v[44:45], v13 offset:160
    ds_read_b64_tr_b16 v[46:47], v13 offset:3744
    v_mfma_f32_16x16x32_bf16 v[124:127], v[72:75], v[92:95], v[124:127]
    ds_read_b64_tr_b16 v[48:49], v13 offset:192
    v_mfma_f32_16x16x32_bf16 v[132:135], v[76:79], v[92:95], v[132:135]
    ds_read_b64_tr_b16 v[50:51], v13 offset:3776
    v_mfma_f32_16x16x32_bf16 v[140:143], v[80:83], v[92:95], v[140:143]
    ds_read_b64_tr_b16 v[56:57], v17 offset:0
    ds_read_b64_tr_b16 v[58:59], v17 offset:1024
    global_load_dwordx4 a[56:59], v254, s[20:21] offset:3072 sc1
    v_add_u32 v254, 4096, v254
    v_mfma_f32_16x16x32_bf16 v[148:151], v[84:87], v[92:95], v[148:151]
    s_mul_i32 s45, s70, 14336
    v_add_u32 v12, s45, v11
    s_waitcnt lgkmcnt(14)
    v_mfma_f32_16x16x32_bf16 v[96:99], v[24:27], v[52:55], v[96:99]
    ds_read_b64_tr_b16 v[88:89], v16 offset:2048
    ds_read_b64_tr_b16 v[90:91], v16 offset:3072
    s_add_u32 m0, s58, 8192
    s_lshl_b32 s45, s71, 12
    v_add_u32 v10, s45, v7
    global_load_lds_dwordx4 v10, s[20:21] sc1
    global_load_lds_dwordx4 v10, s[20:21] offset:1024 sc1
    global_load_lds_dwordx4 v10, s[20:21] offset:2048 sc1
    global_load_lds_dwordx4 v10, s[20:21] offset:3072 sc1
    s_waitcnt lgkmcnt(14)
    v_mfma_f32_16x16x32_bf16 v[104:107], v[28:31], v[52:55], v[104:107]
    ds_read_b64_tr_b16 v[60:61], v13 offset:7168
    s_waitcnt lgkmcnt(13)
    v_mfma_f32_16x16x32_bf16 v[112:115], v[32:35], v[52:55], v[112:115]
    ds_read_b64_tr_b16 v[62:63], v13 offset:10752
    s_waitcnt lgkmcnt(12)
    v_mfma_f32_16x16x32_bf16 v[120:123], v[36:39], v[52:55], v[120:123]
    ds_read_b64_tr_b16 v[64:65], v13 offset:7200
    ds_read_b64_tr_b16 v[66:67], v13 offset:10784
    s_waitcnt lgkmcnt(12)
    v_mfma_f32_16x16x32_bf16 v[128:131], v[40:43], v[52:55], v[128:131]
    ds_read_b64_tr_b16 v[68:69], v13 offset:7232
    global_load_dwordx4 a[60:63], v255, s[20:21] offset:3072 sc1
    v_add_u32 v255, 4096, v255
    s_waitcnt lgkmcnt(11)
    v_mfma_f32_16x16x32_bf16 v[136:139], v[44:47], v[52:55], v[136:139]
    ds_read_b64_tr_b16 v[70:71], v13 offset:10816
    s_waitcnt lgkmcnt(10)
    v_mfma_f32_16x16x32_bf16 v[144:147], v[48:51], v[52:55], v[144:147]
    ds_read_b64_tr_b16 v[72:73], v13 offset:7264
    ds_read_b64_tr_b16 v[74:75], v13 offset:10848
    s_waitcnt lgkmcnt(10)
    v_mfma_f32_16x16x32_bf16 v[100:103], v[24:27], v[56:59], v[100:103]
    ds_read_b64_tr_b16 v[76:77], v13 offset:7296
    v_mfma_f32_16x16x32_bf16 v[108:111], v[28:31], v[56:59], v[108:111]
    ds_read_b64_tr_b16 v[78:79], v13 offset:10880
    global_load_dwordx4 a[64:67], v252, s[20:21] offset:0 sc1
    v_mfma_f32_16x16x32_bf16 v[116:119], v[32:35], v[56:59], v[116:119]
    ds_read_b64_tr_b16 v[80:81], v13 offset:7328
    ds_read_b64_tr_b16 v[82:83], v13 offset:10912
    v_mfma_f32_16x16x32_bf16 v[124:127], v[36:39], v[56:59], v[124:127]
    ds_read_b64_tr_b16 v[84:85], v13 offset:7360
    v_mfma_f32_16x16x32_bf16 v[132:135], v[40:43], v[56:59], v[132:135]
    ds_read_b64_tr_b16 v[86:87], v13 offset:10944
    v_mfma_f32_16x16x32_bf16 v[140:143], v[44:47], v[56:59], v[140:143]
    ds_read_b64_tr_b16 v[92:93], v17 offset:2048
    ds_read_b64_tr_b16 v[94:95], v17 offset:3072
    global_load_dwordx4 a[68:71], v253, s[20:21] offset:0 sc1
    v_mfma_f32_16x16x32_bf16 v[148:151], v[48:51], v[56:59], v[148:151]
    s_waitcnt vmcnt(14)
    s_waitcnt lgkmcnt(14)
    v_mfma_f32_16x16x32_bf16 v[96:99], v[60:63], v[88:91], v[96:99]
    ds_read_b64_tr_b16 v[52:53], v16 offset:4096
    ds_read_b64_tr_b16 v[54:55], v16 offset:5120
    s_waitcnt lgkmcnt(14)
    v_mfma_f32_16x16x32_bf16 v[104:107], v[64:67], v[88:91], v[104:107]
    ds_read_b64_tr_b16 v[24:25], v12 offset:0
    s_waitcnt lgkmcnt(13)
    v_mfma_f32_16x16x32_bf16 v[112:115], v[68:71], v[88:91], v[112:115]
    ds_read_b64_tr_b16 v[26:27], v12 offset:3584
    s_waitcnt lgkmcnt(12)
    v_mfma_f32_16x16x32_bf16 v[120:123], v[72:75], v[88:91], v[120:123]
    ds_read_b64_tr_b16 v[28:29], v12 offset:32
    ds_read_b64_tr_b16 v[30:31], v12 offset:3616
    s_waitcnt lgkmcnt(12)
    v_mfma_f32_16x16x32_bf16 v[128:131], v[76:79], v[88:91], v[128:131]
    ds_read_b64_tr_b16 v[32:33], v12 offset:64
    global_load_dwordx4 a[72:75], v254, s[20:21] offset:0 sc1
    s_waitcnt lgkmcnt(11)
    v_mfma_f32_16x16x32_bf16 v[136:139], v[80:83], v[88:91], v[136:139]
    ds_read_b64_tr_b16 v[34:35], v12 offset:3648
    s_waitcnt lgkmcnt(10)
    v_mfma_f32_16x16x32_bf16 v[144:147], v[84:87], v[88:91], v[144:147]
    ds_read_b64_tr_b16 v[36:37], v12 offset:96
    ds_read_b64_tr_b16 v[38:39], v12 offset:3680
    s_waitcnt lgkmcnt(10)
    v_mfma_f32_16x16x32_bf16 v[100:103], v[60:63], v[92:95], v[100:103]
    ds_read_b64_tr_b16 v[40:41], v12 offset:128
    v_mfma_f32_16x16x32_bf16 v[108:111], v[64:67], v[92:95], v[108:111]
    ds_read_b64_tr_b16 v[42:43], v12 offset:3712
    global_load_dwordx4 a[76:79], v255, s[20:21] offset:0 sc1
    v_mfma_f32_16x16x32_bf16 v[116:119], v[68:71], v[92:95], v[116:119]
    ds_read_b64_tr_b16 v[44:45], v12 offset:160
    ds_read_b64_tr_b16 v[46:47], v12 offset:3744
    v_mfma_f32_16x16x32_bf16 v[124:127], v[72:75], v[92:95], v[124:127]
    ds_read_b64_tr_b16 v[48:49], v12 offset:192
    v_mfma_f32_16x16x32_bf16 v[132:135], v[76:79], v[92:95], v[132:135]
    ds_read_b64_tr_b16 v[50:51], v12 offset:3776
    v_mfma_f32_16x16x32_bf16 v[140:143], v[80:83], v[92:95], v[140:143]
    ds_read_b64_tr_b16 v[56:57], v17 offset:4096
    ds_read_b64_tr_b16 v[58:59], v17 offset:5120
    global_load_dwordx4 a[80:83], v252, s[20:21] offset:1024 sc1
    v_mfma_f32_16x16x32_bf16 v[148:151], v[84:87], v[92:95], v[148:151]
    s_mul_i32 s45, s71, 14336
    v_add_u32 v13, s45, v11
    s_waitcnt lgkmcnt(14)
    v_mfma_f32_16x16x32_bf16 v[96:99], v[24:27], v[52:55], v[96:99]
    ds_read_b64_tr_b16 v[88:89], v16 offset:6144
    ds_read_b64_tr_b16 v[90:91], v16 offset:7168
    s_add_u32 m0, s58, 0
    s_lshl_b32 s45, s72, 12
    v_add_u32 v10, s45, v7
    global_load_lds_dwordx4 v10, s[20:21] sc1
    global_load_lds_dwordx4 v10, s[20:21] offset:1024 sc1
    global_load_lds_dwordx4 v10, s[20:21] offset:2048 sc1
    global_load_lds_dwordx4 v10, s[20:21] offset:3072 sc1
    s_waitcnt lgkmcnt(14)
    v_mfma_f32_16x16x32_bf16 v[104:107], v[28:31], v[52:55], v[104:107]
    ds_read_b64_tr_b16 v[60:61], v12 offset:7168
    s_waitcnt lgkmcnt(13)
    v_mfma_f32_16x16x32_bf16 v[112:115], v[32:35], v[52:55], v[112:115]
    ds_read_b64_tr_b16 v[62:63], v12 offset:10752
    s_waitcnt lgkmcnt(12)
    v_mfma_f32_16x16x32_bf16 v[120:123], v[36:39], v[52:55], v[120:123]
    ds_read_b64_tr_b16 v[64:65], v12 offset:7200
    ds_read_b64_tr_b16 v[66:67], v12 offset:10784
    s_waitcnt lgkmcnt(12)
    v_mfma_f32_16x16x32_bf16 v[128:131], v[40:43], v[52:55], v[128:131]
    ds_read_b64_tr_b16 v[68:69], v12 offset:7232
    global_load_dwordx4 a[84:87], v253, s[20:21] offset:1024 sc1
    s_waitcnt lgkmcnt(11)
    v_mfma_f32_16x16x32_bf16 v[136:139], v[44:47], v[52:55], v[136:139]
    ds_read_b64_tr_b16 v[70:71], v12 offset:10816
    s_waitcnt lgkmcnt(10)
    v_mfma_f32_16x16x32_bf16 v[144:147], v[48:51], v[52:55], v[144:147]
    ds_read_b64_tr_b16 v[72:73], v12 offset:7264
    ds_read_b64_tr_b16 v[74:75], v12 offset:10848
    s_waitcnt lgkmcnt(10)
    v_mfma_f32_16x16x32_bf16 v[100:103], v[24:27], v[56:59], v[100:103]
    ds_read_b64_tr_b16 v[76:77], v12 offset:7296
    v_mfma_f32_16x16x32_bf16 v[108:111], v[28:31], v[56:59], v[108:111]
    ds_read_b64_tr_b16 v[78:79], v12 offset:10880
    global_load_dwordx4 a[88:91], v254, s[20:21] offset:1024 sc1
    v_mfma_f32_16x16x32_bf16 v[116:119], v[32:35], v[56:59], v[116:119]
    ds_read_b64_tr_b16 v[80:81], v12 offset:7328
    ds_read_b64_tr_b16 v[82:83], v12 offset:10912
    v_mfma_f32_16x16x32_bf16 v[124:127], v[36:39], v[56:59], v[124:127]
    ds_read_b64_tr_b16 v[84:85], v12 offset:7360
    v_mfma_f32_16x16x32_bf16 v[132:135], v[40:43], v[56:59], v[132:135]
    ds_read_b64_tr_b16 v[86:87], v12 offset:10944
    v_mfma_f32_16x16x32_bf16 v[140:143], v[44:47], v[56:59], v[140:143]
    ds_read_b64_tr_b16 v[92:93], v17 offset:6144
    ds_read_b64_tr_b16 v[94:95], v17 offset:7168
    global_load_dwordx4 a[92:95], v255, s[20:21] offset:1024 sc1
    v_mfma_f32_16x16x32_bf16 v[148:151], v[48:51], v[56:59], v[148:151]
    s_waitcnt vmcnt(13)
    s_waitcnt lgkmcnt(14)
    v_mfma_f32_16x16x32_bf16 v[96:99], v[60:63], v[88:91], v[96:99]
    ds_read_b64_tr_b16 v[52:53], v16 offset:8192
    ds_read_b64_tr_b16 v[54:55], v16 offset:9216
    s_waitcnt lgkmcnt(14)
    v_mfma_f32_16x16x32_bf16 v[104:107], v[64:67], v[88:91], v[104:107]
    ds_read_b64_tr_b16 v[24:25], v13 offset:0
    s_waitcnt lgkmcnt(13)
    v_mfma_f32_16x16x32_bf16 v[112:115], v[68:71], v[88:91], v[112:115]
    ds_read_b64_tr_b16 v[26:27], v13 offset:3584
    s_waitcnt lgkmcnt(12)
    v_mfma_f32_16x16x32_bf16 v[120:123], v[72:75], v[88:91], v[120:123]
    ds_read_b64_tr_b16 v[28:29], v13 offset:32
    ds_read_b64_tr_b16 v[30:31], v13 offset:3616
    s_waitcnt lgkmcnt(12)
    v_mfma_f32_16x16x32_bf16 v[128:131], v[76:79], v[88:91], v[128:131]
    ds_read_b64_tr_b16 v[32:33], v13 offset:64
    global_load_dwordx4 a[96:99], v252, s[20:21] offset:2048 sc1
    s_waitcnt lgkmcnt(11)
    v_mfma_f32_16x16x32_bf16 v[136:139], v[80:83], v[88:91], v[136:139]
    ds_read_b64_tr_b16 v[34:35], v13 offset:3648
    s_waitcnt lgkmcnt(10)
    v_mfma_f32_16x16x32_bf16 v[144:147], v[84:87], v[88:91], v[144:147]
    ds_read_b64_tr_b16 v[36:37], v13 offset:96
    ds_read_b64_tr_b16 v[38:39], v13 offset:3680
    s_waitcnt lgkmcnt(10)
    v_mfma_f32_16x16x32_bf16 v[100:103], v[60:63], v[92:95], v[100:103]
    ds_read_b64_tr_b16 v[40:41], v13 offset:128
    v_mfma_f32_16x16x32_bf16 v[108:111], v[64:67], v[92:95], v[108:111]
    ds_read_b64_tr_b16 v[42:43], v13 offset:3712
    global_load_dwordx4 a[100:103], v253, s[20:21] offset:2048 sc1
    v_mfma_f32_16x16x32_bf16 v[116:119], v[68:71], v[92:95], v[116:119]
    ds_read_b64_tr_b16 v[44:45], v13 offset:160
    ds_read_b64_tr_b16 v[46:47], v13 offset:3744
    v_mfma_f32_16x16x32_bf16 v[124:127], v[72:75], v[92:95], v[124:127]
    ds_read_b64_tr_b16 v[48:49], v13 offset:192
    v_mfma_f32_16x16x32_bf16 v[132:135], v[76:79], v[92:95], v[132:135]
    ds_read_b64_tr_b16 v[50:51], v13 offset:3776
    v_mfma_f32_16x16x32_bf16 v[140:143], v[80:83], v[92:95], v[140:143]
    ds_read_b64_tr_b16 v[56:57], v17 offset:8192
    ds_read_b64_tr_b16 v[58:59], v17 offset:9216
    global_load_dwordx4 a[104:107], v254, s[20:21] offset:2048 sc1
    v_mfma_f32_16x16x32_bf16 v[148:151], v[84:87], v[92:95], v[148:151]
    s_mul_i32 s45, s72, 14336
    v_add_u32 v12, s45, v11
    s_waitcnt lgkmcnt(14)
    v_mfma_f32_16x16x32_bf16 v[96:99], v[24:27], v[52:55], v[96:99]
    ds_read_b64_tr_b16 v[88:89], v16 offset:10240
    ds_read_b64_tr_b16 v[90:91], v16 offset:11264
    s_add_u32 m0, s58, 4096
    s_lshl_b32 s45, s73, 12
    v_add_u32 v10, s45, v7
    global_load_lds_dwordx4 v10, s[20:21] sc1
    global_load_lds_dwordx4 v10, s[20:21] offset:1024 sc1
    global_load_lds_dwordx4 v10, s[20:21] offset:2048 sc1
    global_load_lds_dwordx4 v10, s[20:21] offset:3072 sc1
    s_waitcnt lgkmcnt(14)
    v_mfma_f32_16x16x32_bf16 v[104:107], v[28:31], v[52:55], v[104:107]
    ds_read_b64_tr_b16 v[60:61], v13 offset:7168
    s_waitcnt lgkmcnt(13)
    v_mfma_f32_16x16x32_bf16 v[112:115], v[32:35], v[52:55], v[112:115]
    ds_read_b64_tr_b16 v[62:63], v13 offset:10752
    s_waitcnt lgkmcnt(12)
    v_mfma_f32_16x16x32_bf16 v[120:123], v[36:39], v[52:55], v[120:123]
    ds_read_b64_tr_b16 v[64:65], v13 offset:7200
    ds_read_b64_tr_b16 v[66:67], v13 offset:10784
    s_waitcnt lgkmcnt(12)
    v_mfma_f32_16x16x32_bf16 v[128:131], v[40:43], v[52:55], v[128:131]
    ds_read_b64_tr_b16 v[68:69], v13 offset:7232
    global_load_dwordx4 a[108:111], v255, s[20:21] offset:2048 sc1
    s_waitcnt lgkmcnt(11)
    v_mfma_f32_16x16x32_bf16 v[136:139], v[44:47], v[52:55], v[136:139]
    ds_read_b64_tr_b16 v[70:71], v13 offset:10816
    s_waitcnt lgkmcnt(10)
    v_mfma_f32_16x16x32_bf16 v[144:147], v[48:51], v[52:55], v[144:147]
    ds_read_b64_tr_b16 v[72:73], v13 offset:7264
    ds_read_b64_tr_b16 v[74:75], v13 offset:10848
    s_waitcnt lgkmcnt(10)
    v_mfma_f32_16x16x32_bf16 v[100:103], v[24:27], v[56:59], v[100:103]
    ds_read_b64_tr_b16 v[76:77], v13 offset:7296
    v_mfma_f32_16x16x32_bf16 v[108:111], v[28:31], v[56:59], v[108:111]
    ds_read_b64_tr_b16 v[78:79], v13 offset:10880
    global_load_dwordx4 a[112:115], v252, s[20:21] offset:3072 sc1
    v_add_u32 v252, 4096, v252
    v_mfma_f32_16x16x32_bf16 v[116:119], v[32:35], v[56:59], v[116:119]
    ds_read_b64_tr_b16 v[80:81], v13 offset:7328
    ds_read_b64_tr_b16 v[82:83], v13 offset:10912
    v_mfma_f32_16x16x32_bf16 v[124:127], v[36:39], v[56:59], v[124:127]
    ds_read_b64_tr_b16 v[84:85], v13 offset:7360
    v_mfma_f32_16x16x32_bf16 v[132:135], v[40:43], v[56:59], v[132:135]
    ds_read_b64_tr_b16 v[86:87], v13 offset:10944
    v_mfma_f32_16x16x32_bf16 v[140:143], v[44:47], v[56:59], v[140:143]
    ds_read_b64_tr_b16 v[92:93], v17 offset:10240
    ds_read_b64_tr_b16 v[94:95], v17 offset:11264
    global_load_dwordx4 a[116:119], v253, s[20:21] offset:3072 sc1
    v_add_u32 v253, 4096, v253
    v_mfma_f32_16x16x32_bf16 v[148:151], v[48:51], v[56:59], v[148:151]
    s_waitcnt vmcnt(13)
    s_waitcnt lgkmcnt(14)
    v_mfma_f32_16x16x32_bf16 v[96:99], v[60:63], v[88:91], v[96:99]
    ds_read_b64_tr_b16 v[52:53], v16 offset:0
    ds_read_b64_tr_b16 v[54:55], v16 offset:1024
    s_waitcnt lgkmcnt(14)
    v_mfma_f32_16x16x32_bf16 v[104:107], v[64:67], v[88:91], v[104:107]
    ds_read_b64_tr_b16 v[24:25], v12 offset:0
    s_waitcnt lgkmcnt(13)
    v_mfma_f32_16x16x32_bf16 v[112:115], v[68:71], v[88:91], v[112:115]
    ds_read_b64_tr_b16 v[26:27], v12 offset:3584
    s_waitcnt lgkmcnt(12)
    v_mfma_f32_16x16x32_bf16 v[120:123], v[72:75], v[88:91], v[120:123]
    ds_read_b64_tr_b16 v[28:29], v12 offset:32
    ds_read_b64_tr_b16 v[30:31], v12 offset:3616
    s_waitcnt lgkmcnt(12)
    v_mfma_f32_16x16x32_bf16 v[128:131], v[76:79], v[88:91], v[128:131]
    ds_read_b64_tr_b16 v[32:33], v12 offset:64
    global_load_dwordx4 a[120:123], v254, s[20:21] offset:3072 sc1
    v_add_u32 v254, 4096, v254
    s_waitcnt lgkmcnt(11)
    v_mfma_f32_16x16x32_bf16 v[136:139], v[80:83], v[88:91], v[136:139]
    ds_read_b64_tr_b16 v[34:35], v12 offset:3648
    s_waitcnt lgkmcnt(10)
    v_mfma_f32_16x16x32_bf16 v[144:147], v[84:87], v[88:91], v[144:147]
    ds_read_b64_tr_b16 v[36:37], v12 offset:96
    ds_read_b64_tr_b16 v[38:39], v12 offset:3680
    s_waitcnt lgkmcnt(10)
    v_mfma_f32_16x16x32_bf16 v[100:103], v[60:63], v[92:95], v[100:103]
    ds_read_b64_tr_b16 v[40:41], v12 offset:128
    v_mfma_f32_16x16x32_bf16 v[108:111], v[64:67], v[92:95], v[108:111]
    ds_read_b64_tr_b16 v[42:43], v12 offset:3712
    global_load_dwordx4 a[124:127], v255, s[20:21] offset:3072 sc1
    v_add_u32 v255, 4096, v255
    v_mfma_f32_16x16x32_bf16 v[116:119], v[68:71], v[92:95], v[116:119]
    ds_read_b64_tr_b16 v[44:45], v12 offset:160
    ds_read_b64_tr_b16 v[46:47], v12 offset:3744
    v_mfma_f32_16x16x32_bf16 v[124:127], v[72:75], v[92:95], v[124:127]
    ds_read_b64_tr_b16 v[48:49], v12 offset:192
    v_mfma_f32_16x16x32_bf16 v[132:135], v[76:79], v[92:95], v[132:135]
    ds_read_b64_tr_b16 v[50:51], v12 offset:3776
    v_mfma_f32_16x16x32_bf16 v[140:143], v[80:83], v[92:95], v[140:143]
    ds_read_b64_tr_b16 v[56:57], v17 offset:0
    ds_read_b64_tr_b16 v[58:59], v17 offset:1024
    global_load_dwordx4 a[128:131], v252, s[20:21] offset:0 sc1
    v_mfma_f32_16x16x32_bf16 v[148:151], v[84:87], v[92:95], v[148:151]
    v_add_u32 v250, 4096, v248
    global_load_dwordx4 v[152:155], v248, s[20:21] offset:0 sc1
    global_load_dwordx4 v[156:159], v248, s[20:21] offset:2048 sc1
    global_load_dwordx4 v[160:163], v250, s[20:21] offset:0 sc1
    global_load_dwordx4 v[164:167], v250, s[20:21] offset:2048 sc1
    global_load_dwordx4 v[168:171], v248, s[20:21] offset:256 sc1
    global_load_dwordx4 v[172:175], v248, s[20:21] offset:2304 sc1
    global_load_dwordx4 v[176:179], v250, s[20:21] offset:256 sc1
    global_load_dwordx4 v[180:183], v250, s[20:21] offset:2304 sc1
    s_mul_i32 s45, s73, 14336
    v_add_u32 v13, s45, v11
    s_waitcnt lgkmcnt(14)
    v_mfma_f32_16x16x32_bf16 v[96:99], v[24:27], v[52:55], v[96:99]
    ds_read_b64_tr_b16 v[88:89], v16 offset:2048
    ds_read_b64_tr_b16 v[90:91], v16 offset:3072
    s_waitcnt lgkmcnt(14)
    v_mfma_f32_16x16x32_bf16 v[104:107], v[28:31], v[52:55], v[104:107]
    ds_read_b64_tr_b16 v[60:61], v12 offset:7168
    s_waitcnt lgkmcnt(13)
    v_mfma_f32_16x16x32_bf16 v[112:115], v[32:35], v[52:55], v[112:115]
    ds_read_b64_tr_b16 v[62:63], v12 offset:10752
    s_waitcnt lgkmcnt(12)
    v_mfma_f32_16x16x32_bf16 v[120:123], v[36:39], v[52:55], v[120:123]
    ds_read_b64_tr_b16 v[64:65], v12 offset:7200
    ds_read_b64_tr_b16 v[66:67], v12 offset:10784
    s_waitcnt lgkmcnt(12)
    v_mfma_f32_16x16x32_bf16 v[128:131], v[40:43], v[52:55], v[128:131]
    ds_read_b64_tr_b16 v[68:69], v12 offset:7232
    global_load_dwordx4 a[132:135], v253, s[20:21] offset:0 sc1
    s_waitcnt lgkmcnt(11)
    v_mfma_f32_16x16x32_bf16 v[136:139], v[44:47], v[52:55], v[136:139]
    ds_read_b64_tr_b16 v[70:71], v12 offset:10816
    s_waitcnt lgkmcnt(10)
    v_mfma_f32_16x16x32_bf16 v[144:147], v[48:51], v[52:55], v[144:147]
    ds_read_b64_tr_b16 v[72:73], v12 offset:7264
    ds_read_b64_tr_b16 v[74:75], v12 offset:10848
    s_waitcnt lgkmcnt(10)
    v_mfma_f32_16x16x32_bf16 v[100:103], v[24:27], v[56:59], v[100:103]
    ds_read_b64_tr_b16 v[76:77], v12 offset:7296
    v_mfma_f32_16x16x32_bf16 v[108:111], v[28:31], v[56:59], v[108:111]
    ds_read_b64_tr_b16 v[78:79], v12 offset:10880
    global_load_dwordx4 a[136:139], v254, s[20:21] offset:0 sc1
    v_mfma_f32_16x16x32_bf16 v[116:119], v[32:35], v[56:59], v[116:119]
    ds_read_b64_tr_b16 v[80:81], v12 offset:7328
    ds_read_b64_tr_b16 v[82:83], v12 offset:10912
    v_mfma_f32_16x16x32_bf16 v[124:127], v[36:39], v[56:59], v[124:127]
    ds_read_b64_tr_b16 v[84:85], v12 offset:7360
    v_mfma_f32_16x16x32_bf16 v[132:135], v[40:43], v[56:59], v[132:135]
    ds_read_b64_tr_b16 v[86:87], v12 offset:10944
    v_mfma_f32_16x16x32_bf16 v[140:143], v[44:47], v[56:59], v[140:143]
    ds_read_b64_tr_b16 v[92:93], v17 offset:2048
    ds_read_b64_tr_b16 v[94:95], v17 offset:3072
    global_load_dwordx4 a[140:143], v255, s[20:21] offset:0 sc1
    v_mfma_f32_16x16x32_bf16 v[148:151], v[48:51], v[56:59], v[148:151]
    s_waitcnt vmcnt(17)
    s_waitcnt lgkmcnt(14)
    v_mfma_f32_16x16x32_bf16 v[96:99], v[60:63], v[88:91], v[96:99]
    ds_read_b64_tr_b16 v[52:53], v16 offset:4096
    ds_read_b64_tr_b16 v[54:55], v16 offset:5120
    s_waitcnt lgkmcnt(14)
    v_mfma_f32_16x16x32_bf16 v[104:107], v[64:67], v[88:91], v[104:107]
    ds_read_b64_tr_b16 v[24:25], v13 offset:0
    s_waitcnt lgkmcnt(13)
    v_mfma_f32_16x16x32_bf16 v[112:115], v[68:71], v[88:91], v[112:115]
    ds_read_b64_tr_b16 v[26:27], v13 offset:3584
    s_waitcnt lgkmcnt(12)
    v_mfma_f32_16x16x32_bf16 v[120:123], v[72:75], v[88:91], v[120:123]
    ds_read_b64_tr_b16 v[28:29], v13 offset:32
    ds_read_b64_tr_b16 v[30:31], v13 offset:3616
    s_waitcnt lgkmcnt(12)
    v_mfma_f32_16x16x32_bf16 v[128:131], v[76:79], v[88:91], v[128:131]
    ds_read_b64_tr_b16 v[32:33], v13 offset:64
    global_load_dwordx4 a[144:147], v252, s[20:21] offset:1024 sc1
    s_waitcnt lgkmcnt(11)
    v_mfma_f32_16x16x32_bf16 v[136:139], v[80:83], v[88:91], v[136:139]
    ds_read_b64_tr_b16 v[34:35], v13 offset:3648
    s_waitcnt lgkmcnt(10)
    v_mfma_f32_16x16x32_bf16 v[144:147], v[84:87], v[88:91], v[144:147]
    ds_read_b64_tr_b16 v[36:37], v13 offset:96
    ds_read_b64_tr_b16 v[38:39], v13 offset:3680
    s_waitcnt lgkmcnt(10)
    v_mfma_f32_16x16x32_bf16 v[100:103], v[60:63], v[92:95], v[100:103]
    ds_read_b64_tr_b16 v[40:41], v13 offset:128
    v_mfma_f32_16x16x32_bf16 v[108:111], v[64:67], v[92:95], v[108:111]
    ds_read_b64_tr_b16 v[42:43], v13 offset:3712
    global_load_dwordx4 a[148:151], v253, s[20:21] offset:1024 sc1
    v_mfma_f32_16x16x32_bf16 v[116:119], v[68:71], v[92:95], v[116:119]
    ds_read_b64_tr_b16 v[44:45], v13 offset:160
    ds_read_b64_tr_b16 v[46:47], v13 offset:3744
    v_mfma_f32_16x16x32_bf16 v[124:127], v[72:75], v[92:95], v[124:127]
    ds_read_b64_tr_b16 v[48:49], v13 offset:192
    v_mfma_f32_16x16x32_bf16 v[132:135], v[76:79], v[92:95], v[132:135]
    ds_read_b64_tr_b16 v[50:51], v13 offset:3776
    v_mfma_f32_16x16x32_bf16 v[140:143], v[80:83], v[92:95], v[140:143]
    ds_read_b64_tr_b16 v[56:57], v17 offset:4096
    ds_read_b64_tr_b16 v[58:59], v17 offset:5120
    global_load_dwordx4 a[152:155], v254, s[20:21] offset:1024 sc1
    v_mfma_f32_16x16x32_bf16 v[148:151], v[84:87], v[92:95], v[148:151]
    s_waitcnt lgkmcnt(14)
    v_mfma_f32_16x16x32_bf16 v[96:99], v[24:27], v[52:55], v[96:99]
    ds_read_b64_tr_b16 v[88:89], v16 offset:6144
    ds_read_b64_tr_b16 v[90:91], v16 offset:7168
    s_waitcnt lgkmcnt(14)
    v_mfma_f32_16x16x32_bf16 v[104:107], v[28:31], v[52:55], v[104:107]
    ds_read_b64_tr_b16 v[60:61], v13 offset:7168
    s_waitcnt lgkmcnt(13)
    v_mfma_f32_16x16x32_bf16 v[112:115], v[32:35], v[52:55], v[112:115]
    ds_read_b64_tr_b16 v[62:63], v13 offset:10752
    s_waitcnt lgkmcnt(12)
    v_mfma_f32_16x16x32_bf16 v[120:123], v[36:39], v[52:55], v[120:123]
    ds_read_b64_tr_b16 v[64:65], v13 offset:7200
    ds_read_b64_tr_b16 v[66:67], v13 offset:10784
    s_waitcnt lgkmcnt(12)
    v_mfma_f32_16x16x32_bf16 v[128:131], v[40:43], v[52:55], v[128:131]
    ds_read_b64_tr_b16 v[68:69], v13 offset:7232
    global_load_dwordx4 a[156:159], v255, s[20:21] offset:1024 sc1
    s_waitcnt lgkmcnt(11)
    v_mfma_f32_16x16x32_bf16 v[136:139], v[44:47], v[52:55], v[136:139]
    ds_read_b64_tr_b16 v[70:71], v13 offset:10816
    s_waitcnt lgkmcnt(10)
    v_mfma_f32_16x16x32_bf16 v[144:147], v[48:51], v[52:55], v[144:147]
    ds_read_b64_tr_b16 v[72:73], v13 offset:7264
    ds_read_b64_tr_b16 v[74:75], v13 offset:10848
    s_waitcnt lgkmcnt(10)
    v_mfma_f32_16x16x32_bf16 v[100:103], v[24:27], v[56:59], v[100:103]
    ds_read_b64_tr_b16 v[76:77], v13 offset:7296
    v_mfma_f32_16x16x32_bf16 v[108:111], v[28:31], v[56:59], v[108:111]
    ds_read_b64_tr_b16 v[78:79], v13 offset:10880
    global_load_dwordx4 a[160:163], v252, s[20:21] offset:2048 sc1
    v_mfma_f32_16x16x32_bf16 v[116:119], v[32:35], v[56:59], v[116:119]
    ds_read_b64_tr_b16 v[80:81], v13 offset:7328
    ds_read_b64_tr_b16 v[82:83], v13 offset:10912
    v_mfma_f32_16x16x32_bf16 v[124:127], v[36:39], v[56:59], v[124:127]
    ds_read_b64_tr_b16 v[84:85], v13 offset:7360
    v_mfma_f32_16x16x32_bf16 v[132:135], v[40:43], v[56:59], v[132:135]
    ds_read_b64_tr_b16 v[86:87], v13 offset:10944
    v_mfma_f32_16x16x32_bf16 v[140:143], v[44:47], v[56:59], v[140:143]
    ds_read_b64_tr_b16 v[92:93], v17 offset:6144
    ds_read_b64_tr_b16 v[94:95], v17 offset:7168
    global_load_dwordx4 a[164:167], v253, s[20:21] offset:2048 sc1
    v_mfma_f32_16x16x32_bf16 v[148:151], v[48:51], v[56:59], v[148:151]
    s_waitcnt lgkmcnt(14)
    v_mfma_f32_16x16x32_bf16 v[96:99], v[60:63], v[88:91], v[96:99]
    s_waitcnt lgkmcnt(12)
    v_mfma_f32_16x16x32_bf16 v[104:107], v[64:67], v[88:91], v[104:107]
    s_waitcnt lgkmcnt(10)
    v_mfma_f32_16x16x32_bf16 v[112:115], v[68:71], v[88:91], v[112:115]
    s_waitcnt lgkmcnt(8)
    v_mfma_f32_16x16x32_bf16 v[120:123], v[72:75], v[88:91], v[120:123]
    s_waitcnt lgkmcnt(6)
    v_mfma_f32_16x16x32_bf16 v[128:131], v[76:79], v[88:91], v[128:131]
    global_load_dwordx4 a[168:171], v254, s[20:21] offset:2048 sc1
    s_waitcnt lgkmcnt(4)
    v_mfma_f32_16x16x32_bf16 v[136:139], v[80:83], v[88:91], v[136:139]
    s_waitcnt lgkmcnt(2)
    v_mfma_f32_16x16x32_bf16 v[144:147], v[84:87], v[88:91], v[144:147]
    s_waitcnt lgkmcnt(0)
    v_mfma_f32_16x16x32_bf16 v[100:103], v[60:63], v[92:95], v[100:103]
    v_mfma_f32_16x16x32_bf16 v[108:111], v[64:67], v[92:95], v[108:111]
    global_load_dwordx4 a[172:175], v255, s[20:21] offset:2048 sc1
    v_mfma_f32_16x16x32_bf16 v[116:119], v[68:71], v[92:95], v[116:119]
    v_mfma_f32_16x16x32_bf16 v[124:127], v[72:75], v[92:95], v[124:127]
    v_mfma_f32_16x16x32_bf16 v[132:135], v[76:79], v[92:95], v[132:135]
    v_mfma_f32_16x16x32_bf16 v[140:143], v[80:83], v[92:95], v[140:143]
    v_mfma_f32_16x16x32_bf16 v[148:151], v[84:87], v[92:95], v[148:151]
    s_waitcnt vmcnt(11)
    v_cmp_eq_u32 vcc, s38, v153
    v_cmp_eq_u32 s[52:53], s38, v155
    s_nop 0
    s_and_b64 vcc, vcc, s[52:53]
    v_cmp_eq_u32 s[52:53], s38, v157
    s_nop 0
    s_and_b64 vcc, vcc, s[52:53]
    v_cmp_eq_u32 s[52:53], s38, v159
    s_nop 0
    s_and_b64 vcc, vcc, s[52:53]
    v_cmp_eq_u32 s[52:53], s38, v161
    s_nop 0
    s_and_b64 vcc, vcc, s[52:53]
    v_cmp_eq_u32 s[52:53], s38, v163
    s_nop 0
    s_and_b64 vcc, vcc, s[52:53]
    v_cmp_eq_u32 s[52:53], s38, v165
    s_nop 0
    s_and_b64 vcc, vcc, s[52:53]
    v_cmp_eq_u32 s[52:53], s38, v167
    s_nop 0
    s_and_b64 vcc, vcc, s[52:53]
    v_cmp_eq_u32 s[52:53], s38, v169
    s_nop 0
    s_and_b64 vcc, vcc, s[52:53]
    v_cmp_eq_u32 s[52:53], s38, v171
    s_nop 0
    s_and_b64 vcc, vcc, s[52:53]
    v_cmp_eq_u32 s[52:53], s38, v173
    s_nop 0
    s_and_b64 vcc, vcc, s[52:53]
    v_cmp_eq_u32 s[52:53], s38, v175
    s_nop 0
    s_and_b64 vcc, vcc, s[52:53]
    v_cmp_eq_u32 s[52:53], s38, v177
    s_nop 0
    s_and_b64 vcc, vcc, s[52:53]
    v_cmp_eq_u32 s[52:53], s38, v179
    s_nop 0
    s_and_b64 vcc, vcc, s[52:53]
    v_cmp_eq_u32 s[52:53], s38, v181
    s_nop 0
    s_and_b64 vcc, vcc, s[52:53]
    v_cmp_eq_u32 s[52:53], s38, v183
    s_nop 0
    s_and_b64 vcc, vcc, s[52:53]
    s_cmp_eq_u64 vcc, -1
    s_cbranch_scc1 sequential_preLN__ssm_conv_s4__mixer_channel_mlp__prompt_kernel_ps_ok
    s_mov_b32 s79, 200000
sequential_preLN__ssm_conv_s4__mixer_channel_mlp__prompt_kernel_ps:
    global_load_dwordx4 v[152:155], v248, s[20:21] offset:0 sc1
    global_load_dwordx4 v[156:159], v248, s[20:21] offset:2048 sc1
    global_load_dwordx4 v[160:163], v250, s[20:21] offset:0 sc1
    global_load_dwordx4 v[164:167], v250, s[20:21] offset:2048 sc1
    global_load_dwordx4 v[168:171], v248, s[20:21] offset:256 sc1
    global_load_dwordx4 v[172:175], v248, s[20:21] offset:2304 sc1
    global_load_dwordx4 v[176:179], v250, s[20:21] offset:256 sc1
    global_load_dwordx4 v[180:183], v250, s[20:21] offset:2304 sc1
    s_waitcnt vmcnt(0)
    v_cmp_eq_u32 vcc, s38, v153
    v_cmp_eq_u32 s[52:53], s38, v155
    s_nop 0
    s_and_b64 vcc, vcc, s[52:53]
    v_cmp_eq_u32 s[52:53], s38, v157
    s_nop 0
    s_and_b64 vcc, vcc, s[52:53]
    v_cmp_eq_u32 s[52:53], s38, v159
    s_nop 0
    s_and_b64 vcc, vcc, s[52:53]
    v_cmp_eq_u32 s[52:53], s38, v161
    s_nop 0
    s_and_b64 vcc, vcc, s[52:53]
    v_cmp_eq_u32 s[52:53], s38, v163
    s_nop 0
    s_and_b64 vcc, vcc, s[52:53]
    v_cmp_eq_u32 s[52:53], s38, v165
    s_nop 0
    s_and_b64 vcc, vcc, s[52:53]
    v_cmp_eq_u32 s[52:53], s38, v167
    s_nop 0
    s_and_b64 vcc, vcc, s[52:53]
    v_cmp_eq_u32 s[52:53], s38, v169
    s_nop 0
    s_and_b64 vcc, vcc, s[52:53]
    v_cmp_eq_u32 s[52:53], s38, v171
    s_nop 0
    s_and_b64 vcc, vcc, s[52:53]
    v_cmp_eq_u32 s[52:53], s38, v173
    s_nop 0
    s_and_b64 vcc, vcc, s[52:53]
    v_cmp_eq_u32 s[52:53], s38, v175
    s_nop 0
    s_and_b64 vcc, vcc, s[52:53]
    v_cmp_eq_u32 s[52:53], s38, v177
    s_nop 0
    s_and_b64 vcc, vcc, s[52:53]
    v_cmp_eq_u32 s[52:53], s38, v179
    s_nop 0
    s_and_b64 vcc, vcc, s[52:53]
    v_cmp_eq_u32 s[52:53], s38, v181
    s_nop 0
    s_and_b64 vcc, vcc, s[52:53]
    v_cmp_eq_u32 s[52:53], s38, v183
    s_nop 0
    s_and_b64 vcc, vcc, s[52:53]
    s_cmp_eq_u64 vcc, -1
    s_cbranch_scc1 sequential_preLN__ssm_conv_s4__mixer_channel_mlp__prompt_kernel_ps_ok
    s_sub_u32 s79, s79, 1
    s_cmp_eq_u32 s79, 0
    s_cbranch_scc0 sequential_preLN__ssm_conv_s4__mixer_channel_mlp__prompt_kernel_ps
sequential_preLN__ssm_conv_s4__mixer_channel_mlp__prompt_kernel_ps_ok:
    v_add_f32 v36, v152, v156
    v_add_f32 v38, v160, v164
    v_add_f32 v32, v154, v158
    v_add_f32 v40, v162, v166
    v_add_f32 v37, v168, v172
    v_add_f32 v39, v176, v180
    v_add_f32 v33, v170, v174
    v_add_f32 v41, v178, v182
    v_add_f32 v36, v36, v38
    v_add_f32 v32, v32, v40
    v_add_f32 v37, v37, v39
    v_add_f32 v33, v33, v41
    v_mov_b32 v34, v32
    v_mov_b32 v38, v36
    v_mov_b32 v35, v33
    v_mov_b32 v39, v37
    v_permlane16_swap_b32 v32, v34
    v_permlane16_swap_b32 v36, v38
    v_permlane16_swap_b32 v33, v35
    v_permlane16_swap_b32 v37, v39
    v_add_f32 v32, v32, v34
    v_add_f32 v36, v36, v38
    v_add_f32 v33, v33, v35
    v_add_f32 v37, v37, v39
    v_mov_b32 v34, v32
    v_mov_b32 v38, v36
    v_mov_b32 v35, v33
    v_mov_b32 v39, v37
    v_permlane32_swap_b32 v32, v34
    v_permlane32_swap_b32 v36, v38
    v_permlane32_swap_b32 v33, v35
    v_permlane32_swap_b32 v37, v39
    v_add_f32 v32, v32, v34
    v_add_f32 v36, v36, v38
    v_add_f32 v33, v33, v35
    v_add_f32 v37, v37, v39
    v_mul_f32 v44, 0x3b000000, v36
    v_mul_f32 v52, 0x3b000000, v37
    v_mul_f32 v45, 0x3b000000, v32
    v_mul_f32 v53, 0x3b000000, v33
    v_fma_f32 v45, -v44, v44, v45
    v_fma_f32 v53, -v52, v52, v53
    v_max_f32 v45, 0, v45
    v_max_f32 v53, 0, v53
    v_cvt_pk_bf16_f32 v46, v44, v44
    v_cvt_pk_bf16_f32 v54, v52, v52
    v_cvt_pk_bf16_f32 v48, v45, v45
    v_cvt_pk_bf16_f32 v56, v53, v53
    v_lshlrev_b32 v46, 16, v46
    v_lshlrev_b32 v54, 16, v54
    v_lshlrev_b32 v48, 16, v48
    v_lshlrev_b32 v56, 16, v56
    v_add_f32 v48, 0x3727c5ac, v48
    v_add_f32 v56, 0x3727c5ac, v56
    v_cvt_pk_bf16_f32 v48, v48, v48
    v_cvt_pk_bf16_f32 v56, v56, v56
    v_lshlrev_b32 v48, 16, v48
    v_lshlrev_b32 v56, 16, v56
    v_sqrt_f32 v48, v48
    v_sqrt_f32 v56, v56
    v_sub_f32 v49, v44, v46
    v_sub_f32 v57, v52, v54
    v_cvt_pk_bf16_f32 v48, v48, v48
    v_cvt_pk_bf16_f32 v56, v56, v56
    v_lshlrev_b32 v48, 16, v48
    v_lshlrev_b32 v56, 16, v56
    v_rcp_f32 v47, v48
    v_rcp_f32 v55, v56
    v_mul_f32 v49, v49, v47
    v_mul_f32 v57, v57, v55
    v_mul_f32 v48, v45, v47
    v_mul_f32 v56, v53, v55
    v_cvt_pk_bf16_f32 v49, v49, v49
    v_cvt_pk_bf16_f32 v57, v57, v57
    v_mul_f32 v48, v48, v47
    v_mul_f32 v56, v56, v55
    v_lshlrev_b32 v49, 16, v49
    v_lshlrev_b32 v57, 16, v57
    v_cvt_pk_bf16_f32 v48, v48, v48
    v_cvt_pk_bf16_f32 v56, v56, v56
    v_lshlrev_b32 v48, 16, v48
    v_lshlrev_b32 v56, 16, v56
    v_add_f32 v48, 0x3727c5ac, v48
    v_add_f32 v56, 0x3727c5ac, v56
    v_cvt_pk_bf16_f32 v48, v48, v48
    v_cvt_pk_bf16_f32 v56, v56, v56
    v_lshlrev_b32 v48, 16, v48
    v_lshlrev_b32 v56, 16, v56
    v_sqrt_f32 v48, v48
    v_sqrt_f32 v56, v56
    v_cvt_pk_bf16_f32 v48, v48, v48
    v_cvt_pk_bf16_f32 v56, v56, v56
    v_lshlrev_b32 v48, 16, v48
    v_lshlrev_b32 v56, 16, v56
    v_rcp_f32 v50, v48
    v_rcp_f32 v58, v56
    v_fma_f32 v48, v46, v47, v49
    v_fma_f32 v56, v54, v55, v57
    v_mul_f32 v60, v47, v50
    v_mul_f32 v62, v55, v58
    v_mul_f32 v48, v48, v50
    v_mul_f32 v56, v56, v58
    v_sub_f32 v61, 0, v48
    v_sub_f32 v63, 0, v56
    v_mov_b32 v64, 0xc0135761
    v_mov_b32 v65, 0xc0135761
    v_mov_b32 v66, 0xbdd2d3e8
    v_mov_b32 v67, 0xbdd2d3e8
    s_lshl_b32 s45, s54, 3
    s_lshl_b32 s46, s22, 1
    s_add_u32 s45, s45, s46
    s_mul_i32 s45, s45, 57344
    s_mul_i32 s46, s55, 7
    s_lshr_b32 s47, s46, 1
    s_lshl_b32 s47, s47, 10
    s_add_u32 s45, s45, s47
    s_add_u32 s45, s45, 11534336
    v_add_u32 v10, s45, v5
    v_add_u32 v11, 57344, v10
    v_lshlrev_b32 v12, 3, v2
    v_add_u32 v12, s45, v12
    v_add_u32 v13, 57344, v12
    s_and_b32 s46, s55, 1
sequential_preLN__ssm_conv_s4__mixer_channel_mlp__prompt_kernel_gslow:
    v_lshlrev_b32 v68, 16, v228
    v_and_b32 v69, 0xffff0000, v228
    v_lshlrev_b32 v70, 16, v229
    v_and_b32 v71, 0xffff0000, v229
    v_pk_fma_f32 v[72:73], v[200:201], v[60:61], v[68:69] op_sel:[0,1,0] op_sel_hi:[1,1,1]
    v_pk_fma_f32 v[74:75], v[202:203], v[60:61], v[70:71] op_sel:[0,1,0] op_sel_hi:[1,1,1]
    v_pk_fma_f32 v[76:77], v[200:201], v[62:63], v[68:69] op_sel:[0,1,0] op_sel_hi:[1,1,1]
    v_pk_fma_f32 v[78:79], v[202:203], v[62:63], v[70:71] op_sel:[0,1,0] op_sel_hi:[1,1,1]
    v_pk_fma_f32 v[96:97], v[96:97], v[60:61], v[72:73] op_sel:[0,0,0] op_sel_hi:[1,0,1]
    v_pk_fma_f32 v[98:99], v[98:99], v[60:61], v[74:75] op_sel:[0,0,0] op_sel_hi:[1,0,1]
    v_pk_fma_f32 v[100:101], v[100:101], v[62:63], v[76:77] op_sel:[0,0,0] op_sel_hi:[1,0,1]
    v_pk_fma_f32 v[102:103], v[102:103], v[62:63], v[78:79] op_sel:[0,0,0] op_sel_hi:[1,0,1]
    v_pk_mul_f32 v[72:73], v[96:97], v[96:97]
    v_pk_mul_f32 v[74:75], v[98:99], v[98:99]
    v_pk_mul_f32 v[76:77], v[100:101], v[100:101]
    v_pk_mul_f32 v[78:79], v[102:103], v[102:103]
    v_pk_fma_f32 v[72:73], v[72:73], v[66:67], v[64:65]
    v_pk_fma_f32 v[74:75], v[74:75], v[66:67], v[64:65]
    v_pk_fma_f32 v[76:77], v[76:77], v[66:67], v[64:65]
    v_pk_fma_f32 v[78:79], v[78:79], v[66:67], v[64:65]
    v_pk_mul_f32 v[72:73], v[72:73], v[96:97]
    v_pk_mul_f32 v[74:75], v[74:75], v[98:99]
    v_pk_mul_f32 v[76:77], v[76:77], v[100:101]
    v_pk_mul_f32 v[78:79], v[78:79], v[102:103]
    v_exp_f32 v72, v72
    v_exp_f32 v73, v73
    v_exp_f32 v74, v74
    v_exp_f32 v75, v75
    v_exp_f32 v76, v76
    v_exp_f32 v77, v77
    v_exp_f32 v78, v78
    v_exp_f32 v79, v79
    v_pk_add_f32 v[72:73], v[72:73], 1.0 op_sel_hi:[1,0]
    v_pk_add_f32 v[74:75], v[74:75], 1.0 op_sel_hi:[1,0]
    v_pk_add_f32 v[76:77], v[76:77], 1.0 op_sel_hi:[1,0]
    v_pk_add_f32 v[78:79], v[78:79], 1.0 op_sel_hi:[1,0]
    v_rcp_f32 v72, v72
    v_rcp_f32 v73, v73
    v_rcp_f32 v74, v74
    v_rcp_f32 v75, v75
    v_rcp_f32 v76, v76
    v_rcp_f32 v77, v77
    v_rcp_f32 v78, v78
    v_rcp_f32 v79, v79
    v_pk_mul_f32 v[96:97], v[96:97], v[72:73]
    v_pk_mul_f32 v[98:99], v[98:99], v[74:75]
    v_pk_mul_f32 v[100:101], v[100:101], v[76:77]
    v_pk_mul_f32 v[102:103], v[102:103], v[78:79]
    v_cvt_pk_bf16_f32 v168, v96, v97
    v_cvt_pk_bf16_f32 v169, v98, v99
    v_cvt_pk_bf16_f32 v184, v100, v101
    v_cvt_pk_bf16_f32 v185, v102, v103
    s_cmp_eq_u32 s46, 0
    s_cbranch_scc1 sequential_preLN__ssm_conv_s4__mixer_channel_mlp__prompt_kernel_sos0
    global_store_dwordx2 v12, v[168:169], s[20:21] offset:512 sc1
    global_store_dwordx2 v13, v[184:185], s[20:21] offset:512 sc1
sequential_preLN__ssm_conv_s4__mixer_channel_mlp__prompt_kernel_sos0:
    v_lshlrev_b32 v68, 16, v230
    v_and_b32 v69, 0xffff0000, v230
    v_lshlrev_b32 v70, 16, v231
    v_and_b32 v71, 0xffff0000, v231
    v_pk_fma_f32 v[72:73], v[204:205], v[60:61], v[68:69] op_sel:[0,1,0] op_sel_hi:[1,1,1]
    v_pk_fma_f32 v[74:75], v[206:207], v[60:61], v[70:71] op_sel:[0,1,0] op_sel_hi:[1,1,1]
    v_pk_fma_f32 v[76:77], v[204:205], v[62:63], v[68:69] op_sel:[0,1,0] op_sel_hi:[1,1,1]
    v_pk_fma_f32 v[78:79], v[206:207], v[62:63], v[70:71] op_sel:[0,1,0] op_sel_hi:[1,1,1]
    v_pk_fma_f32 v[104:105], v[104:105], v[60:61], v[72:73] op_sel:[0,0,0] op_sel_hi:[1,0,1]
    v_pk_fma_f32 v[106:107], v[106:107], v[60:61], v[74:75] op_sel:[0,0,0] op_sel_hi:[1,0,1]
    v_pk_fma_f32 v[108:109], v[108:109], v[62:63], v[76:77] op_sel:[0,0,0] op_sel_hi:[1,0,1]
    v_pk_fma_f32 v[110:111], v[110:111], v[62:63], v[78:79] op_sel:[0,0,0] op_sel_hi:[1,0,1]
    v_pk_mul_f32 v[72:73], v[104:105], v[104:105]
    v_pk_mul_f32 v[74:75], v[106:107], v[106:107]
    v_pk_mul_f32 v[76:77], v[108:109], v[108:109]
    v_pk_mul_f32 v[78:79], v[110:111], v[110:111]
    v_pk_fma_f32 v[72:73], v[72:73], v[66:67], v[64:65]
    v_pk_fma_f32 v[74:75], v[74:75], v[66:67], v[64:65]
    v_pk_fma_f32 v[76:77], v[76:77], v[66:67], v[64:65]
    v_pk_fma_f32 v[78:79], v[78:79], v[66:67], v[64:65]
    v_pk_mul_f32 v[72:73], v[72:73], v[104:105]
    v_pk_mul_f32 v[74:75], v[74:75], v[106:107]
    v_pk_mul_f32 v[76:77], v[76:77], v[108:109]
    v_pk_mul_f32 v[78:79], v[78:79], v[110:111]
    v_exp_f32 v72, v72
    v_exp_f32 v73, v73
    v_exp_f32 v74, v74
    v_exp_f32 v75, v75
    v_exp_f32 v76, v76
    v_exp_f32 v77, v77
    v_exp_f32 v78, v78
    v_exp_f32 v79, v79
    v_pk_add_f32 v[72:73], v[72:73], 1.0 op_sel_hi:[1,0]
    v_pk_add_f32 v[74:75], v[74:75], 1.0 op_sel_hi:[1,0]
    v_pk_add_f32 v[76:77], v[76:77], 1.0 op_sel_hi:[1,0]
    v_pk_add_f32 v[78:79], v[78:79], 1.0 op_sel_hi:[1,0]
    v_rcp_f32 v72, v72
    v_rcp_f32 v73, v73
    v_rcp_f32 v74, v74
    v_rcp_f32 v75, v75
    v_rcp_f32 v76, v76
    v_rcp_f32 v77, v77
    v_rcp_f32 v78, v78
    v_rcp_f32 v79, v79
    v_pk_mul_f32 v[104:105], v[104:105], v[72:73]
    v_pk_mul_f32 v[106:107], v[106:107], v[74:75]
    v_pk_mul_f32 v[108:109], v[108:109], v[76:77]
    v_pk_mul_f32 v[110:111], v[110:111], v[78:79]
    v_cvt_pk_bf16_f32 v170, v104, v105
    v_cvt_pk_bf16_f32 v171, v106, v107
    v_cvt_pk_bf16_f32 v186, v108, v109
    v_cvt_pk_bf16_f32 v187, v110, v111
    s_cmp_eq_u32 s46, 0
    s_cbranch_scc0 sequential_preLN__ssm_conv_s4__mixer_channel_mlp__prompt_kernel_ses1
    global_store_dwordx4 v10, v[168:171], s[20:21] offset:0 sc1
    global_store_dwordx4 v11, v[184:187], s[20:21] offset:0 sc1
sequential_preLN__ssm_conv_s4__mixer_channel_mlp__prompt_kernel_ses1:
    v_lshlrev_b32 v68, 16, v232
    v_and_b32 v69, 0xffff0000, v232
    v_lshlrev_b32 v70, 16, v233
    v_and_b32 v71, 0xffff0000, v233
    v_pk_fma_f32 v[72:73], v[208:209], v[60:61], v[68:69] op_sel:[0,1,0] op_sel_hi:[1,1,1]
    v_pk_fma_f32 v[74:75], v[210:211], v[60:61], v[70:71] op_sel:[0,1,0] op_sel_hi:[1,1,1]
    v_pk_fma_f32 v[76:77], v[208:209], v[62:63], v[68:69] op_sel:[0,1,0] op_sel_hi:[1,1,1]
    v_pk_fma_f32 v[78:79], v[210:211], v[62:63], v[70:71] op_sel:[0,1,0] op_sel_hi:[1,1,1]
    v_pk_fma_f32 v[112:113], v[112:113], v[60:61], v[72:73] op_sel:[0,0,0] op_sel_hi:[1,0,1]
    v_pk_fma_f32 v[114:115], v[114:115], v[60:61], v[74:75] op_sel:[0,0,0] op_sel_hi:[1,0,1]
    v_pk_fma_f32 v[116:117], v[116:117], v[62:63], v[76:77] op_sel:[0,0,0] op_sel_hi:[1,0,1]
    v_pk_fma_f32 v[118:119], v[118:119], v[62:63], v[78:79] op_sel:[0,0,0] op_sel_hi:[1,0,1]
    v_pk_mul_f32 v[72:73], v[112:113], v[112:113]
    v_pk_mul_f32 v[74:75], v[114:115], v[114:115]
    v_pk_mul_f32 v[76:77], v[116:117], v[116:117]
    v_pk_mul_f32 v[78:79], v[118:119], v[118:119]
    v_pk_fma_f32 v[72:73], v[72:73], v[66:67], v[64:65]
    v_pk_fma_f32 v[74:75], v[74:75], v[66:67], v[64:65]
    v_pk_fma_f32 v[76:77], v[76:77], v[66:67], v[64:65]
    v_pk_fma_f32 v[78:79], v[78:79], v[66:67], v[64:65]
    v_pk_mul_f32 v[72:73], v[72:73], v[112:113]
    v_pk_mul_f32 v[74:75], v[74:75], v[114:115]
    v_pk_mul_f32 v[76:77], v[76:77], v[116:117]
    v_pk_mul_f32 v[78:79], v[78:79], v[118:119]
    v_exp_f32 v72, v72
    v_exp_f32 v73, v73
    v_exp_f32 v74, v74
    v_exp_f32 v75, v75
    v_exp_f32 v76, v76
    v_exp_f32 v77, v77
    v_exp_f32 v78, v78
    v_exp_f32 v79, v79
    v_pk_add_f32 v[72:73], v[72:73], 1.0 op_sel_hi:[1,0]
    v_pk_add_f32 v[74:75], v[74:75], 1.0 op_sel_hi:[1,0]
    v_pk_add_f32 v[76:77], v[76:77], 1.0 op_sel_hi:[1,0]
    v_pk_add_f32 v[78:79], v[78:79], 1.0 op_sel_hi:[1,0]
    v_rcp_f32 v72, v72
    v_rcp_f32 v73, v73
    v_rcp_f32 v74, v74
    v_rcp_f32 v75, v75
    v_rcp_f32 v76, v76
    v_rcp_f32 v77, v77
    v_rcp_f32 v78, v78
    v_rcp_f32 v79, v79
    v_pk_mul_f32 v[112:113], v[112:113], v[72:73]
    v_pk_mul_f32 v[114:115], v[114:115], v[74:75]
    v_pk_mul_f32 v[116:117], v[116:117], v[76:77]
    v_pk_mul_f32 v[118:119], v[118:119], v[78:79]
    v_cvt_pk_bf16_f32 v172, v112, v113
    v_cvt_pk_bf16_f32 v173, v114, v115
    v_cvt_pk_bf16_f32 v188, v116, v117
    v_cvt_pk_bf16_f32 v189, v118, v119
    s_cmp_eq_u32 s46, 0
    s_cbranch_scc1 sequential_preLN__ssm_conv_s4__mixer_channel_mlp__prompt_kernel_sos2
    global_store_dwordx4 v10, v[170:173], s[20:21] offset:1024 sc1
    global_store_dwordx4 v11, v[186:189], s[20:21] offset:1024 sc1
sequential_preLN__ssm_conv_s4__mixer_channel_mlp__prompt_kernel_sos2:
    v_lshlrev_b32 v68, 16, v234
    v_and_b32 v69, 0xffff0000, v234
    v_lshlrev_b32 v70, 16, v235
    v_and_b32 v71, 0xffff0000, v235
    v_pk_fma_f32 v[72:73], v[212:213], v[60:61], v[68:69] op_sel:[0,1,0] op_sel_hi:[1,1,1]
    v_pk_fma_f32 v[74:75], v[214:215], v[60:61], v[70:71] op_sel:[0,1,0] op_sel_hi:[1,1,1]
    v_pk_fma_f32 v[76:77], v[212:213], v[62:63], v[68:69] op_sel:[0,1,0] op_sel_hi:[1,1,1]
    v_pk_fma_f32 v[78:79], v[214:215], v[62:63], v[70:71] op_sel:[0,1,0] op_sel_hi:[1,1,1]
    v_pk_fma_f32 v[120:121], v[120:121], v[60:61], v[72:73] op_sel:[0,0,0] op_sel_hi:[1,0,1]
    v_pk_fma_f32 v[122:123], v[122:123], v[60:61], v[74:75] op_sel:[0,0,0] op_sel_hi:[1,0,1]
    v_pk_fma_f32 v[124:125], v[124:125], v[62:63], v[76:77] op_sel:[0,0,0] op_sel_hi:[1,0,1]
    v_pk_fma_f32 v[126:127], v[126:127], v[62:63], v[78:79] op_sel:[0,0,0] op_sel_hi:[1,0,1]
    v_pk_mul_f32 v[72:73], v[120:121], v[120:121]
    v_pk_mul_f32 v[74:75], v[122:123], v[122:123]
    v_pk_mul_f32 v[76:77], v[124:125], v[124:125]
    v_pk_mul_f32 v[78:79], v[126:127], v[126:127]
    v_pk_fma_f32 v[72:73], v[72:73], v[66:67], v[64:65]
    v_pk_fma_f32 v[74:75], v[74:75], v[66:67], v[64:65]
    v_pk_fma_f32 v[76:77], v[76:77], v[66:67], v[64:65]
    v_pk_fma_f32 v[78:79], v[78:79], v[66:67], v[64:65]
    v_pk_mul_f32 v[72:73], v[72:73], v[120:121]
    v_pk_mul_f32 v[74:75], v[74:75], v[122:123]
    v_pk_mul_f32 v[76:77], v[76:77], v[124:125]
    v_pk_mul_f32 v[78:79], v[78:79], v[126:127]
    v_exp_f32 v72, v72
    v_exp_f32 v73, v73
    v_exp_f32 v74, v74
    v_exp_f32 v75, v75
    v_exp_f32 v76, v76
    v_exp_f32 v77, v77
    v_exp_f32 v78, v78
    v_exp_f32 v79, v79
    v_pk_add_f32 v[72:73], v[72:73], 1.0 op_sel_hi:[1,0]
    v_pk_add_f32 v[74:75], v[74:75], 1.0 op_sel_hi:[1,0]
    v_pk_add_f32 v[76:77], v[76:77], 1.0 op_sel_hi:[1,0]
    v_pk_add_f32 v[78:79], v[78:79], 1.0 op_sel_hi:[1,0]
    v_rcp_f32 v72, v72
    v_rcp_f32 v73, v73
    v_rcp_f32 v74, v74
    v_rcp_f32 v75, v75
    v_rcp_f32 v76, v76
    v_rcp_f32 v77, v77
    v_rcp_f32 v78, v78
    v_rcp_f32 v79, v79
    v_pk_mul_f32 v[120:121], v[120:121], v[72:73]
    v_pk_mul_f32 v[122:123], v[122:123], v[74:75]
    v_pk_mul_f32 v[124:125], v[124:125], v[76:77]
    v_pk_mul_f32 v[126:127], v[126:127], v[78:79]
    v_cvt_pk_bf16_f32 v174, v120, v121
    v_cvt_pk_bf16_f32 v175, v122, v123
    v_cvt_pk_bf16_f32 v190, v124, v125
    v_cvt_pk_bf16_f32 v191, v126, v127
    s_cmp_eq_u32 s46, 0
    s_cbranch_scc0 sequential_preLN__ssm_conv_s4__mixer_channel_mlp__prompt_kernel_ses3
    global_store_dwordx4 v10, v[172:175], s[20:21] offset:1024 sc1
    global_store_dwordx4 v11, v[188:191], s[20:21] offset:1024 sc1
sequential_preLN__ssm_conv_s4__mixer_channel_mlp__prompt_kernel_ses3:
    v_lshlrev_b32 v68, 16, v236
    v_and_b32 v69, 0xffff0000, v236
    v_lshlrev_b32 v70, 16, v237
    v_and_b32 v71, 0xffff0000, v237
    v_pk_fma_f32 v[72:73], v[216:217], v[60:61], v[68:69] op_sel:[0,1,0] op_sel_hi:[1,1,1]
    v_pk_fma_f32 v[74:75], v[218:219], v[60:61], v[70:71] op_sel:[0,1,0] op_sel_hi:[1,1,1]
    v_pk_fma_f32 v[76:77], v[216:217], v[62:63], v[68:69] op_sel:[0,1,0] op_sel_hi:[1,1,1]
    v_pk_fma_f32 v[78:79], v[218:219], v[62:63], v[70:71] op_sel:[0,1,0] op_sel_hi:[1,1,1]
    v_pk_fma_f32 v[128:129], v[128:129], v[60:61], v[72:73] op_sel:[0,0,0] op_sel_hi:[1,0,1]
    v_pk_fma_f32 v[130:131], v[130:131], v[60:61], v[74:75] op_sel:[0,0,0] op_sel_hi:[1,0,1]
    v_pk_fma_f32 v[132:133], v[132:133], v[62:63], v[76:77] op_sel:[0,0,0] op_sel_hi:[1,0,1]
    v_pk_fma_f32 v[134:135], v[134:135], v[62:63], v[78:79] op_sel:[0,0,0] op_sel_hi:[1,0,1]
    v_pk_mul_f32 v[72:73], v[128:129], v[128:129]
    v_pk_mul_f32 v[74:75], v[130:131], v[130:131]
    v_pk_mul_f32 v[76:77], v[132:133], v[132:133]
    v_pk_mul_f32 v[78:79], v[134:135], v[134:135]
    v_pk_fma_f32 v[72:73], v[72:73], v[66:67], v[64:65]
    v_pk_fma_f32 v[74:75], v[74:75], v[66:67], v[64:65]
    v_pk_fma_f32 v[76:77], v[76:77], v[66:67], v[64:65]
    v_pk_fma_f32 v[78:79], v[78:79], v[66:67], v[64:65]
    v_pk_mul_f32 v[72:73], v[72:73], v[128:129]
    v_pk_mul_f32 v[74:75], v[74:75], v[130:131]
    v_pk_mul_f32 v[76:77], v[76:77], v[132:133]
    v_pk_mul_f32 v[78:79], v[78:79], v[134:135]
    v_exp_f32 v72, v72
    v_exp_f32 v73, v73
    v_exp_f32 v74, v74
    v_exp_f32 v75, v75
    v_exp_f32 v76, v76
    v_exp_f32 v77, v77
    v_exp_f32 v78, v78
    v_exp_f32 v79, v79
    v_pk_add_f32 v[72:73], v[72:73], 1.0 op_sel_hi:[1,0]
    v_pk_add_f32 v[74:75], v[74:75], 1.0 op_sel_hi:[1,0]
    v_pk_add_f32 v[76:77], v[76:77], 1.0 op_sel_hi:[1,0]
    v_pk_add_f32 v[78:79], v[78:79], 1.0 op_sel_hi:[1,0]
    v_rcp_f32 v72, v72
    v_rcp_f32 v73, v73
    v_rcp_f32 v74, v74
    v_rcp_f32 v75, v75
    v_rcp_f32 v76, v76
    v_rcp_f32 v77, v77
    v_rcp_f32 v78, v78
    v_rcp_f32 v79, v79
    v_pk_mul_f32 v[128:129], v[128:129], v[72:73]
    v_pk_mul_f32 v[130:131], v[130:131], v[74:75]
    v_pk_mul_f32 v[132:133], v[132:133], v[76:77]
    v_pk_mul_f32 v[134:135], v[134:135], v[78:79]
    v_cvt_pk_bf16_f32 v176, v128, v129
    v_cvt_pk_bf16_f32 v177, v130, v131
    v_cvt_pk_bf16_f32 v192, v132, v133
    v_cvt_pk_bf16_f32 v193, v134, v135
    s_cmp_eq_u32 s46, 0
    s_cbranch_scc1 sequential_preLN__ssm_conv_s4__mixer_channel_mlp__prompt_kernel_sos4
    global_store_dwordx4 v10, v[174:177], s[20:21] offset:2048 sc1
    global_store_dwordx4 v11, v[190:193], s[20:21] offset:2048 sc1
sequential_preLN__ssm_conv_s4__mixer_channel_mlp__prompt_kernel_sos4:
    v_lshlrev_b32 v68, 16, v238
    v_and_b32 v69, 0xffff0000, v238
    v_lshlrev_b32 v70, 16, v239
    v_and_b32 v71, 0xffff0000, v239
    v_pk_fma_f32 v[72:73], v[220:221], v[60:61], v[68:69] op_sel:[0,1,0] op_sel_hi:[1,1,1]
    v_pk_fma_f32 v[74:75], v[222:223], v[60:61], v[70:71] op_sel:[0,1,0] op_sel_hi:[1,1,1]
    v_pk_fma_f32 v[76:77], v[220:221], v[62:63], v[68:69] op_sel:[0,1,0] op_sel_hi:[1,1,1]
    v_pk_fma_f32 v[78:79], v[222:223], v[62:63], v[70:71] op_sel:[0,1,0] op_sel_hi:[1,1,1]
    v_pk_fma_f32 v[136:137], v[136:137], v[60:61], v[72:73] op_sel:[0,0,0] op_sel_hi:[1,0,1]
    v_pk_fma_f32 v[138:139], v[138:139], v[60:61], v[74:75] op_sel:[0,0,0] op_sel_hi:[1,0,1]
    v_pk_fma_f32 v[140:141], v[140:141], v[62:63], v[76:77] op_sel:[0,0,0] op_sel_hi:[1,0,1]
    v_pk_fma_f32 v[142:143], v[142:143], v[62:63], v[78:79] op_sel:[0,0,0] op_sel_hi:[1,0,1]
    v_pk_mul_f32 v[72:73], v[136:137], v[136:137]
    v_pk_mul_f32 v[74:75], v[138:139], v[138:139]
    v_pk_mul_f32 v[76:77], v[140:141], v[140:141]
    v_pk_mul_f32 v[78:79], v[142:143], v[142:143]
    v_pk_fma_f32 v[72:73], v[72:73], v[66:67], v[64:65]
    v_pk_fma_f32 v[74:75], v[74:75], v[66:67], v[64:65]
    v_pk_fma_f32 v[76:77], v[76:77], v[66:67], v[64:65]
    v_pk_fma_f32 v[78:79], v[78:79], v[66:67], v[64:65]
    v_pk_mul_f32 v[72:73], v[72:73], v[136:137]
    v_pk_mul_f32 v[74:75], v[74:75], v[138:139]
    v_pk_mul_f32 v[76:77], v[76:77], v[140:141]
    v_pk_mul_f32 v[78:79], v[78:79], v[142:143]
    v_exp_f32 v72, v72
    v_exp_f32 v73, v73
    v_exp_f32 v74, v74
    v_exp_f32 v75, v75
    v_exp_f32 v76, v76
    v_exp_f32 v77, v77
    v_exp_f32 v78, v78
    v_exp_f32 v79, v79
    v_pk_add_f32 v[72:73], v[72:73], 1.0 op_sel_hi:[1,0]
    v_pk_add_f32 v[74:75], v[74:75], 1.0 op_sel_hi:[1,0]
    v_pk_add_f32 v[76:77], v[76:77], 1.0 op_sel_hi:[1,0]
    v_pk_add_f32 v[78:79], v[78:79], 1.0 op_sel_hi:[1,0]
    v_rcp_f32 v72, v72
    v_rcp_f32 v73, v73
    v_rcp_f32 v74, v74
    v_rcp_f32 v75, v75
    v_rcp_f32 v76, v76
    v_rcp_f32 v77, v77
    v_rcp_f32 v78, v78
    v_rcp_f32 v79, v79
    v_pk_mul_f32 v[136:137], v[136:137], v[72:73]
    v_pk_mul_f32 v[138:139], v[138:139], v[74:75]
    v_pk_mul_f32 v[140:141], v[140:141], v[76:77]
    v_pk_mul_f32 v[142:143], v[142:143], v[78:79]
    v_cvt_pk_bf16_f32 v178, v136, v137
    v_cvt_pk_bf16_f32 v179, v138, v139
    v_cvt_pk_bf16_f32 v194, v140, v141
    v_cvt_pk_bf16_f32 v195, v142, v143
    s_cmp_eq_u32 s46, 0
    s_cbranch_scc0 sequential_preLN__ssm_conv_s4__mixer_channel_mlp__prompt_kernel_ses5
    global_store_dwordx4 v10, v[176:179], s[20:21] offset:2048 sc1
    global_store_dwordx4 v11, v[192:195], s[20:21] offset:2048 sc1
sequential_preLN__ssm_conv_s4__mixer_channel_mlp__prompt_kernel_ses5:
    v_lshlrev_b32 v68, 16, v240
    v_and_b32 v69, 0xffff0000, v240
    v_lshlrev_b32 v70, 16, v241
    v_and_b32 v71, 0xffff0000, v241
    v_pk_fma_f32 v[72:73], v[224:225], v[60:61], v[68:69] op_sel:[0,1,0] op_sel_hi:[1,1,1]
    v_pk_fma_f32 v[74:75], v[226:227], v[60:61], v[70:71] op_sel:[0,1,0] op_sel_hi:[1,1,1]
    v_pk_fma_f32 v[76:77], v[224:225], v[62:63], v[68:69] op_sel:[0,1,0] op_sel_hi:[1,1,1]
    v_pk_fma_f32 v[78:79], v[226:227], v[62:63], v[70:71] op_sel:[0,1,0] op_sel_hi:[1,1,1]
    v_pk_fma_f32 v[144:145], v[144:145], v[60:61], v[72:73] op_sel:[0,0,0] op_sel_hi:[1,0,1]
    v_pk_fma_f32 v[146:147], v[146:147], v[60:61], v[74:75] op_sel:[0,0,0] op_sel_hi:[1,0,1]
    v_pk_fma_f32 v[148:149], v[148:149], v[62:63], v[76:77] op_sel:[0,0,0] op_sel_hi:[1,0,1]
    v_pk_fma_f32 v[150:151], v[150:151], v[62:63], v[78:79] op_sel:[0,0,0] op_sel_hi:[1,0,1]
    v_pk_mul_f32 v[72:73], v[144:145], v[144:145]
    v_pk_mul_f32 v[74:75], v[146:147], v[146:147]
    v_pk_mul_f32 v[76:77], v[148:149], v[148:149]
    v_pk_mul_f32 v[78:79], v[150:151], v[150:151]
    v_pk_fma_f32 v[72:73], v[72:73], v[66:67], v[64:65]
    v_pk_fma_f32 v[74:75], v[74:75], v[66:67], v[64:65]
    v_pk_fma_f32 v[76:77], v[76:77], v[66:67], v[64:65]
    v_pk_fma_f32 v[78:79], v[78:79], v[66:67], v[64:65]
    v_pk_mul_f32 v[72:73], v[72:73], v[144:145]
    v_pk_mul_f32 v[74:75], v[74:75], v[146:147]
    v_pk_mul_f32 v[76:77], v[76:77], v[148:149]
    v_pk_mul_f32 v[78:79], v[78:79], v[150:151]
    v_exp_f32 v72, v72
    v_exp_f32 v73, v73
    v_exp_f32 v74, v74
    v_exp_f32 v75, v75
    v_exp_f32 v76, v76
    v_exp_f32 v77, v77
    v_exp_f32 v78, v78
    v_exp_f32 v79, v79
    v_pk_add_f32 v[72:73], v[72:73], 1.0 op_sel_hi:[1,0]
    v_pk_add_f32 v[74:75], v[74:75], 1.0 op_sel_hi:[1,0]
    v_pk_add_f32 v[76:77], v[76:77], 1.0 op_sel_hi:[1,0]
    v_pk_add_f32 v[78:79], v[78:79], 1.0 op_sel_hi:[1,0]
    v_rcp_f32 v72, v72
    v_rcp_f32 v73, v73
    v_rcp_f32 v74, v74
    v_rcp_f32 v75, v75
    v_rcp_f32 v76, v76
    v_rcp_f32 v77, v77
    v_rcp_f32 v78, v78
    v_rcp_f32 v79, v79
    v_pk_mul_f32 v[144:145], v[144:145], v[72:73]
    v_pk_mul_f32 v[146:147], v[146:147], v[74:75]
    v_pk_mul_f32 v[148:149], v[148:149], v[76:77]
    v_pk_mul_f32 v[150:151], v[150:151], v[78:79]
    v_cvt_pk_bf16_f32 v180, v144, v145
    v_cvt_pk_bf16_f32 v181, v146, v147
    v_cvt_pk_bf16_f32 v196, v148, v149
    v_cvt_pk_bf16_f32 v197, v150, v151
    s_cmp_eq_u32 s46, 0
    s_cbranch_scc0 sequential_preLN__ssm_conv_s4__mixer_channel_mlp__prompt_kernel_ses6
    global_store_dwordx2 v12, v[180:181], s[20:21] offset:3072 sc1
    global_store_dwordx2 v13, v[196:197], s[20:21] offset:3072 sc1
sequential_preLN__ssm_conv_s4__mixer_channel_mlp__prompt_kernel_ses6:
    s_cmp_eq_u32 s46, 0
    s_cbranch_scc1 sequential_preLN__ssm_conv_s4__mixer_channel_mlp__prompt_kernel_sos6
    global_store_dwordx4 v10, v[178:181], s[20:21] offset:3072 sc1
    global_store_dwordx4 v11, v[194:197], s[20:21] offset:3072 sc1
sequential_preLN__ssm_conv_s4__mixer_channel_mlp__prompt_kernel_sos6:
sequential_preLN__ssm_conv_s4__mixer_channel_mlp__prompt_kernel_gdone:
    s_lshl_b32 s45, s54, 4
    s_add_u32 s45, s45, s55
    s_lshl_b32 s45, s45, 6
    s_lshl_b32 s46, s22, 2
    s_add_u32 s45, s45, s46
    s_add_u32 s45, s45, 81920
    v_mov_b32 v6, s45
    v_mov_b32 v7, s38
    s_waitcnt vmcnt(0)
    s_mov_b64 s[52:53], exec
    s_mov_b64 exec, 1
    global_store_dword v6, v7, s[20:21] sc1
    s_mov_b64 exec, s[52:53]
    s_barrier
    global_load_dwordx4 a[176:179], v252, s[20:21] offset:3072 sc1
    v_add_u32 v252, 4096, v252
    global_load_dwordx4 a[180:183], v253, s[20:21] offset:3072 sc1
    v_add_u32 v253, 4096, v253
    global_load_dwordx4 a[184:187], v254, s[20:21] offset:3072 sc1
    v_add_u32 v254, 4096, v254
    global_load_dwordx4 a[188:191], v255, s[20:21] offset:3072 sc1
    v_add_u32 v255, 4096, v255
    global_load_dwordx4 a[192:195], v252, s[20:21] offset:0 sc1
    global_load_dwordx4 a[196:199], v253, s[20:21] offset:0 sc1
    global_load_dwordx4 a[200:203], v254, s[20:21] offset:0 sc1
    global_load_dwordx4 a[204:207], v255, s[20:21] offset:0 sc1
    global_load_dwordx4 a[208:211], v252, s[20:21] offset:1024 sc1
    global_load_dwordx4 a[212:215], v253, s[20:21] offset:1024 sc1
    global_load_dwordx4 a[216:219], v254, s[20:21] offset:1024 sc1
    global_load_dwordx4 a[220:223], v255, s[20:21] offset:1024 sc1
    s_lshr_b32 s60, s26, 3
    s_lshl_b32 s45, s23, 2
    s_add_u32 s60, s60, s45
    s_lshl_b32 s45, s60, 16
    s_lshl_b32 s46, s59, 12
    s_add_u32 s45, s45, s46
    s_lshl_b32 s46, s22, 10
    s_add_u32 s45, s45, s46
    s_add_u32 s45, s45, 5242880
    v_add_u32 v6, s45, v5
    s_lshl_b32 s61, s22, 11
    s_add_u32 s61, s61, 49152
    s_mov_b32 m0, s61
    v_add_u32 v7, 32768, v6
    global_load_lds_dwordx4 v6, s[20:21] sc1
    s_add_u32 m0, s61, 1024
    s_nop 0
    global_load_lds_dwordx4 v7, s[20:21] sc1
    s_lshl_b32 s46, s59, 7
    s_lshl_b32 s47, s22, 5
    s_add_u32 s46, s46, s47
    v_lshlrev_b32 v7, 3, v4
    v_add_u32 v7, s46, v7
    global_load_dwordx2 v[12:13], v7, s[34:35]
    s_lshl_b32 s45, s60, 6
    v_add_u32 v6, s45, v3
    v_lshlrev_b32 v6, 10, v6
    v_add_u32 v14, v6, v7
    s_mul_i32 s45, s60, 224
    s_mul_i32 s46, s22, 14
    s_add_u32 s45, s45, s46
    s_lshl_b32 s45, s45, 10
    s_add_u32 s45, s45, 11534336
    v_add_u32 v8, 0, v5
    v_add_u32 v8, s45, v8
    v_add_u32 v9, 57344, v5
    v_add_u32 v9, s45, v9
    v_add_u32 v10, 114688, v5
    v_add_u32 v10, s45, v10
    v_add_u32 v11, 172032, v5
    v_add_u32 v11, s45, v11
    v_lshlrev_b32 v244, 3, v2
    s_cmp_eq_u32 s22, 3
    s_cbranch_scc0 sequential_preLN__ssm_conv_s4__mixer_channel_mlp__prompt_kernel_np3
    s_lshr_b32 s45, s60, 1
    s_lshl_b32 s45, s45, 10
    s_add_u32 s45, s45, 81920
    s_and_b32 s46, s60, 1
    s_lshl_b32 s46, s46, 3
    s_add_u32 s45, s45, s46
    v_lshlrev_b32 v6, 6, v3
    v_add_u32 v6, s45, v6
    s_mov_b32 s79, 200000
sequential_preLN__ssm_conv_s4__mixer_channel_mlp__prompt_kernel_p3:
    global_load_dwordx2 v[30:31], v6, s[20:21] sc1
    s_waitcnt vmcnt(0)
    v_cmp_eq_u32 vcc, s38, v30
    v_cmp_eq_u32 s[52:53], s38, v31
    s_nop 0
    s_and_b64 vcc, vcc, s[52:53]
    s_cmp_eq_u64 vcc, -1
    s_cbranch_scc1 sequential_preLN__ssm_conv_s4__mixer_channel_mlp__prompt_kernel_p3_ok
    s_sub_u32 s79, s79, 1
    s_cmp_eq_u32 s79, 0
    s_cbranch_scc0 sequential_preLN__ssm_conv_s4__mixer_channel_mlp__prompt_kernel_p3
sequential_preLN__ssm_conv_s4__mixer_channel_mlp__prompt_kernel_p3_ok:
sequential_preLN__ssm_conv_s4__mixer_channel_mlp__prompt_kernel_np3:
    s_barrier
    global_load_dwordx4 v[16:19], v8, s[20:21] offset:0 sc1
    global_load_dwordx4 v[20:23], v9, s[20:21] offset:0 sc1
    global_load_dwordx4 v[24:27], v10, s[20:21] offset:0 sc1
    global_load_dwordx4 v[28:31], v11, s[20:21] offset:0 sc1
    global_load_dwordx4 v[32:35], v8, s[20:21] offset:1024 sc1
    global_load_dwordx4 v[36:39], v9, s[20:21] offset:1024 sc1
    global_load_dwordx4 v[40:43], v10, s[20:21] offset:1024 sc1
    global_load_dwordx4 v[44:47], v11, s[20:21] offset:1024 sc1
    global_load_dwordx4 v[48:51], v8, s[20:21] offset:2048 sc1
    global_load_dwordx4 v[52:55], v9, s[20:21] offset:2048 sc1
    global_load_dwordx4 v[56:59], v10, s[20:21] offset:2048 sc1
    global_load_dwordx4 v[60:63], v11, s[20:21] offset:2048 sc1
    s_waitcnt vmcnt(12)
    s_waitcnt vmcnt(11)
    v_mfma_f32_16x16x32_bf16 v[176:179], a[0:3], v[16:19], 0
    v_mfma_f32_16x16x32_bf16 v[192:195], a[4:7], v[16:19], 0
    v_sub_u32 v240, v8, v244
    global_load_dwordx2 v[64:65], v240, s[20:21] offset:3072 sc1
    global_load_dwordx2 v[66:67], v240, s[20:21] offset:3584 sc1
    v_mfma_f32_16x16x32_bf16 v[208:211], a[8:11], v[16:19], 0
    v_mfma_f32_16x16x32_bf16 v[224:227], a[12:15], v[16:19], 0
    v_sub_u32 v241, v9, v244
    global_load_dwordx2 v[68:69], v241, s[20:21] offset:3072 sc1
    global_load_dwordx2 v[70:71], v241, s[20:21] offset:3584 sc1
    s_waitcnt vmcnt(14)
    v_mfma_f32_16x16x32_bf16 v[180:183], a[0:3], v[20:23], 0
    v_mfma_f32_16x16x32_bf16 v[196:199], a[4:7], v[20:23], 0
    v_sub_u32 v242, v10, v244
    global_load_dwordx2 v[72:73], v242, s[20:21] offset:3072 sc1
    global_load_dwordx2 v[74:75], v242, s[20:21] offset:3584 sc1
    v_mfma_f32_16x16x32_bf16 v[212:215], a[8:11], v[20:23], 0
    v_mfma_f32_16x16x32_bf16 v[228:231], a[12:15], v[20:23], 0
    v_sub_u32 v243, v11, v244
    global_load_dwordx2 v[76:77], v243, s[20:21] offset:3072 sc1
    global_load_dwordx2 v[78:79], v243, s[20:21] offset:3584 sc1
    s_waitcnt vmcnt(17)
    v_mfma_f32_16x16x32_bf16 v[184:187], a[0:3], v[24:27], 0
    v_mfma_f32_16x16x32_bf16 v[200:203], a[4:7], v[24:27], 0
    v_add_u32 v8, 4096, v8
    global_load_dwordx4 v[80:83], v8, s[20:21] offset:0 sc1
    v_mfma_f32_16x16x32_bf16 v[216:219], a[8:11], v[24:27], 0
    v_mfma_f32_16x16x32_bf16 v[232:235], a[12:15], v[24:27], 0
    v_add_u32 v9, 4096, v9
    global_load_dwordx4 v[84:87], v9, s[20:21] offset:0 sc1
    s_waitcnt vmcnt(18)
    v_mfma_f32_16x16x32_bf16 v[188:191], a[0:3], v[28:31], 0
    v_mfma_f32_16x16x32_bf16 v[204:207], a[4:7], v[28:31], 0
    v_add_u32 v10, 4096, v10
    global_load_dwordx4 v[88:91], v10, s[20:21] offset:0 sc1
    v_mfma_f32_16x16x32_bf16 v[220:223], a[8:11], v[28:31], 0
    v_mfma_f32_16x16x32_bf16 v[236:239], a[12:15], v[28:31], 0
    v_add_u32 v11, 4096, v11
    global_load_dwordx4 v[92:95], v11, s[20:21] offset:0 sc1
    s_waitcnt vmcnt(19)
    v_mfma_f32_16x16x32_bf16 v[176:179], a[16:19], v[32:35], v[176:179]
    v_mfma_f32_16x16x32_bf16 v[192:195], a[20:23], v[32:35], v[192:195]
    global_load_dwordx4 v[96:99], v8, s[20:21] offset:1024 sc1
    v_mfma_f32_16x16x32_bf16 v[208:211], a[24:27], v[32:35], v[208:211]
    v_mfma_f32_16x16x32_bf16 v[224:227], a[28:31], v[32:35], v[224:227]
    global_load_dwordx4 v[100:103], v9, s[20:21] offset:1024 sc1
    s_waitcnt vmcnt(20)
    v_mfma_f32_16x16x32_bf16 v[180:183], a[16:19], v[36:39], v[180:183]
    v_mfma_f32_16x16x32_bf16 v[196:199], a[20:23], v[36:39], v[196:199]
    global_load_dwordx4 v[104:107], v10, s[20:21] offset:1024 sc1
    v_mfma_f32_16x16x32_bf16 v[212:215], a[24:27], v[36:39], v[212:215]
    v_mfma_f32_16x16x32_bf16 v[228:231], a[28:31], v[36:39], v[228:231]
    global_load_dwordx4 v[108:111], v11, s[20:21] offset:1024 sc1
    s_waitcnt vmcnt(21)
    v_mfma_f32_16x16x32_bf16 v[184:187], a[16:19], v[40:43], v[184:187]
    v_mfma_f32_16x16x32_bf16 v[200:203], a[20:23], v[40:43], v[200:203]
    global_load_dwordx4 v[112:115], v8, s[20:21] offset:2048 sc1
    v_mfma_f32_16x16x32_bf16 v[216:219], a[24:27], v[40:43], v[216:219]
    v_mfma_f32_16x16x32_bf16 v[232:235], a[28:31], v[40:43], v[232:235]
    global_load_dwordx4 v[116:119], v9, s[20:21] offset:2048 sc1
    s_waitcnt vmcnt(22)
    v_mfma_f32_16x16x32_bf16 v[188:191], a[16:19], v[44:47], v[188:191]
    v_mfma_f32_16x16x32_bf16 v[204:207], a[20:23], v[44:47], v[204:207]
    global_load_dwordx4 v[120:123], v10, s[20:21] offset:2048 sc1
    v_mfma_f32_16x16x32_bf16 v[220:223], a[24:27], v[44:47], v[220:223]
    v_mfma_f32_16x16x32_bf16 v[236:239], a[28:31], v[44:47], v[236:239]
    global_load_dwordx4 v[124:127], v11, s[20:21] offset:2048 sc1
    s_waitcnt vmcnt(23)
    v_mfma_f32_16x16x32_bf16 v[176:179], a[32:35], v[48:51], v[176:179]
    v_mfma_f32_16x16x32_bf16 v[192:195], a[36:39], v[48:51], v[192:195]
    v_mfma_f32_16x16x32_bf16 v[208:211], a[40:43], v[48:51], v[208:211]
    v_mfma_f32_16x16x32_bf16 v[224:227], a[44:47], v[48:51], v[224:227]
    global_load_dwordx4 v[16:19], v8, s[20:21] offset:3072 sc1
    s_waitcnt vmcnt(23)
    v_mfma_f32_16x16x32_bf16 v[180:183], a[32:35], v[52:55], v[180:183]
    v_mfma_f32_16x16x32_bf16 v[196:199], a[36:39], v[52:55], v[196:199]
    v_mfma_f32_16x16x32_bf16 v[212:215], a[40:43], v[52:55], v[212:215]
    v_mfma_f32_16x16x32_bf16 v[228:231], a[44:47], v[52:55], v[228:231]
    global_load_dwordx4 v[20:23], v9, s[20:21] offset:3072 sc1
    s_waitcnt vmcnt(23)
    v_mfma_f32_16x16x32_bf16 v[184:187], a[32:35], v[56:59], v[184:187]
    v_mfma_f32_16x16x32_bf16 v[200:203], a[36:39], v[56:59], v[200:203]
    v_mfma_f32_16x16x32_bf16 v[216:219], a[40:43], v[56:59], v[216:219]
    v_mfma_f32_16x16x32_bf16 v[232:235], a[44:47], v[56:59], v[232:235]
    global_load_dwordx4 v[24:27], v10, s[20:21] offset:3072 sc1
    s_waitcnt vmcnt(23)
    v_mfma_f32_16x16x32_bf16 v[188:191], a[32:35], v[60:63], v[188:191]
    v_mfma_f32_16x16x32_bf16 v[204:207], a[36:39], v[60:63], v[204:207]
    v_mfma_f32_16x16x32_bf16 v[220:223], a[40:43], v[60:63], v[220:223]
    v_mfma_f32_16x16x32_bf16 v[236:239], a[44:47], v[60:63], v[236:239]
    global_load_dwordx4 v[28:31], v11, s[20:21] offset:3072 sc1
    s_waitcnt vmcnt(22)
    v_mfma_f32_16x16x32_bf16 v[176:179], a[48:51], v[64:67], v[176:179]
    v_mfma_f32_16x16x32_bf16 v[192:195], a[52:55], v[64:67], v[192:195]
    v_mfma_f32_16x16x32_bf16 v[208:211], a[56:59], v[64:67], v[208:211]
    v_mfma_f32_16x16x32_bf16 v[224:227], a[60:63], v[64:67], v[224:227]
    v_add_u32 v8, 4096, v8
    global_load_dwordx4 v[32:35], v8, s[20:21] offset:0 sc1
    s_waitcnt vmcnt(21)
    v_mfma_f32_16x16x32_bf16 v[180:183], a[48:51], v[68:71], v[180:183]
    v_mfma_f32_16x16x32_bf16 v[196:199], a[52:55], v[68:71], v[196:199]
    v_mfma_f32_16x16x32_bf16 v[212:215], a[56:59], v[68:71], v[212:215]
    v_mfma_f32_16x16x32_bf16 v[228:231], a[60:63], v[68:71], v[228:231]
    v_add_u32 v9, 4096, v9
    global_load_dwordx4 v[36:39], v9, s[20:21] offset:0 sc1
    s_waitcnt vmcnt(20)
    v_mfma_f32_16x16x32_bf16 v[184:187], a[48:51], v[72:75], v[184:187]
    v_mfma_f32_16x16x32_bf16 v[200:203], a[52:55], v[72:75], v[200:203]
    v_mfma_f32_16x16x32_bf16 v[216:219], a[56:59], v[72:75], v[216:219]
    v_mfma_f32_16x16x32_bf16 v[232:235], a[60:63], v[72:75], v[232:235]
    v_add_u32 v10, 4096, v10
    global_load_dwordx4 v[40:43], v10, s[20:21] offset:0 sc1
    s_waitcnt vmcnt(19)
    v_mfma_f32_16x16x32_bf16 v[188:191], a[48:51], v[76:79], v[188:191]
    v_mfma_f32_16x16x32_bf16 v[204:207], a[52:55], v[76:79], v[204:207]
    v_mfma_f32_16x16x32_bf16 v[220:223], a[56:59], v[76:79], v[220:223]
    v_mfma_f32_16x16x32_bf16 v[236:239], a[60:63], v[76:79], v[236:239]
    v_add_u32 v11, 4096, v11
    global_load_dwordx4 v[44:47], v11, s[20:21] offset:0 sc1
    s_waitcnt vmcnt(19)
    v_mfma_f32_16x16x32_bf16 v[176:179], a[64:67], v[80:83], v[176:179]
    v_mfma_f32_16x16x32_bf16 v[192:195], a[68:71], v[80:83], v[192:195]
    v_mfma_f32_16x16x32_bf16 v[208:211], a[72:75], v[80:83], v[208:211]
    v_mfma_f32_16x16x32_bf16 v[224:227], a[76:79], v[80:83], v[224:227]
    global_load_dwordx4 v[48:51], v8, s[20:21] offset:1024 sc1
    s_waitcnt vmcnt(19)
    v_mfma_f32_16x16x32_bf16 v[180:183], a[64:67], v[84:87], v[180:183]
    v_mfma_f32_16x16x32_bf16 v[196:199], a[68:71], v[84:87], v[196:199]
    v_mfma_f32_16x16x32_bf16 v[212:215], a[72:75], v[84:87], v[212:215]
    v_mfma_f32_16x16x32_bf16 v[228:231], a[76:79], v[84:87], v[228:231]
    global_load_dwordx4 v[52:55], v9, s[20:21] offset:1024 sc1
    s_waitcnt vmcnt(19)
    v_mfma_f32_16x16x32_bf16 v[184:187], a[64:67], v[88:91], v[184:187]
    v_mfma_f32_16x16x32_bf16 v[200:203], a[68:71], v[88:91], v[200:203]
    v_mfma_f32_16x16x32_bf16 v[216:219], a[72:75], v[88:91], v[216:219]
    v_mfma_f32_16x16x32_bf16 v[232:235], a[76:79], v[88:91], v[232:235]
    global_load_dwordx4 v[56:59], v10, s[20:21] offset:1024 sc1
    s_waitcnt vmcnt(19)
    v_mfma_f32_16x16x32_bf16 v[188:191], a[64:67], v[92:95], v[188:191]
    v_mfma_f32_16x16x32_bf16 v[204:207], a[68:71], v[92:95], v[204:207]
    v_mfma_f32_16x16x32_bf16 v[220:223], a[72:75], v[92:95], v[220:223]
    v_mfma_f32_16x16x32_bf16 v[236:239], a[76:79], v[92:95], v[236:239]
    global_load_dwordx4 v[60:63], v11, s[20:21] offset:1024 sc1
    s_waitcnt vmcnt(19)
    v_mfma_f32_16x16x32_bf16 v[176:179], a[80:83], v[96:99], v[176:179]
    v_mfma_f32_16x16x32_bf16 v[192:195], a[84:87], v[96:99], v[192:195]
    v_mfma_f32_16x16x32_bf16 v[208:211], a[88:91], v[96:99], v[208:211]
    v_mfma_f32_16x16x32_bf16 v[224:227], a[92:95], v[96:99], v[224:227]
    v_sub_u32 v240, v8, v244
    global_load_dwordx2 v[64:65], v240, s[20:21] offset:2048 sc1
    global_load_dwordx2 v[66:67], v240, s[20:21] offset:2560 sc1
    s_waitcnt vmcnt(20)
    v_mfma_f32_16x16x32_bf16 v[180:183], a[80:83], v[100:103], v[180:183]
    v_mfma_f32_16x16x32_bf16 v[196:199], a[84:87], v[100:103], v[196:199]
    v_mfma_f32_16x16x32_bf16 v[212:215], a[88:91], v[100:103], v[212:215]
    v_mfma_f32_16x16x32_bf16 v[228:231], a[92:95], v[100:103], v[228:231]
    v_sub_u32 v241, v9, v244
    global_load_dwordx2 v[68:69], v241, s[20:21] offset:2048 sc1
    global_load_dwordx2 v[70:71], v241, s[20:21] offset:2560 sc1
    s_waitcnt vmcnt(21)
    v_mfma_f32_16x16x32_bf16 v[184:187], a[80:83], v[104:107], v[184:187]
    v_mfma_f32_16x16x32_bf16 v[200:203], a[84:87], v[104:107], v[200:203]
    v_mfma_f32_16x16x32_bf16 v[216:219], a[88:91], v[104:107], v[216:219]
    v_mfma_f32_16x16x32_bf16 v[232:235], a[92:95], v[104:107], v[232:235]
    v_sub_u32 v242, v10, v244
    global_load_dwordx2 v[72:73], v242, s[20:21] offset:2048 sc1
    global_load_dwordx2 v[74:75], v242, s[20:21] offset:2560 sc1
    s_waitcnt vmcnt(22)
    v_mfma_f32_16x16x32_bf16 v[188:191], a[80:83], v[108:111], v[188:191]
    v_mfma_f32_16x16x32_bf16 v[204:207], a[84:87], v[108:111], v[204:207]
    v_mfma_f32_16x16x32_bf16 v[220:223], a[88:91], v[108:111], v[220:223]
    v_mfma_f32_16x16x32_bf16 v[236:239], a[92:95], v[108:111], v[236:239]
    v_sub_u32 v243, v11, v244
    global_load_dwordx2 v[76:77], v243, s[20:21] offset:2048 sc1
    global_load_dwordx2 v[78:79], v243, s[20:21] offset:2560 sc1
    s_waitcnt vmcnt(23)
    v_mfma_f32_16x16x32_bf16 v[176:179], a[96:99], v[112:115], v[176:179]
    v_mfma_f32_16x16x32_bf16 v[192:195], a[100:103], v[112:115], v[192:195]
    v_mfma_f32_16x16x32_bf16 v[208:211], a[104:107], v[112:115], v[208:211]
    v_mfma_f32_16x16x32_bf16 v[224:227], a[108:111], v[112:115], v[224:227]
    global_load_dwordx4 v[80:83], v8, s[20:21] offset:3072 sc1
    s_waitcnt vmcnt(23)
    v_mfma_f32_16x16x32_bf16 v[180:183], a[96:99], v[116:119], v[180:183]
    v_mfma_f32_16x16x32_bf16 v[196:199], a[100:103], v[116:119], v[196:199]
    v_mfma_f32_16x16x32_bf16 v[212:215], a[104:107], v[116:119], v[212:215]
    v_mfma_f32_16x16x32_bf16 v[228:231], a[108:111], v[116:119], v[228:231]
    global_load_dwordx4 v[84:87], v9, s[20:21] offset:3072 sc1
    s_waitcnt vmcnt(23)
    v_mfma_f32_16x16x32_bf16 v[184:187], a[96:99], v[120:123], v[184:187]
    v_mfma_f32_16x16x32_bf16 v[200:203], a[100:103], v[120:123], v[200:203]
    v_mfma_f32_16x16x32_bf16 v[216:219], a[104:107], v[120:123], v[216:219]
    v_mfma_f32_16x16x32_bf16 v[232:235], a[108:111], v[120:123], v[232:235]
    global_load_dwordx4 v[88:91], v10, s[20:21] offset:3072 sc1
    s_waitcnt vmcnt(23)
    v_mfma_f32_16x16x32_bf16 v[188:191], a[96:99], v[124:127], v[188:191]
    v_mfma_f32_16x16x32_bf16 v[204:207], a[100:103], v[124:127], v[204:207]
    v_mfma_f32_16x16x32_bf16 v[220:223], a[104:107], v[124:127], v[220:223]
    v_mfma_f32_16x16x32_bf16 v[236:239], a[108:111], v[124:127], v[236:239]
    global_load_dwordx4 v[92:95], v11, s[20:21] offset:3072 sc1
    s_waitcnt vmcnt(23)
    v_mfma_f32_16x16x32_bf16 v[176:179], a[112:115], v[16:19], v[176:179]
    v_mfma_f32_16x16x32_bf16 v[192:195], a[116:119], v[16:19], v[192:195]
    v_mfma_f32_16x16x32_bf16 v[208:211], a[120:123], v[16:19], v[208:211]
    v_mfma_f32_16x16x32_bf16 v[224:227], a[124:127], v[16:19], v[224:227]
    v_add_u32 v8, 4096, v8
    global_load_dwordx4 v[96:99], v8, s[20:21] offset:0 sc1
    s_waitcnt vmcnt(23)
    v_mfma_f32_16x16x32_bf16 v[180:183], a[112:115], v[20:23], v[180:183]
    v_mfma_f32_16x16x32_bf16 v[196:199], a[116:119], v[20:23], v[196:199]
    v_mfma_f32_16x16x32_bf16 v[212:215], a[120:123], v[20:23], v[212:215]
    v_mfma_f32_16x16x32_bf16 v[228:231], a[124:127], v[20:23], v[228:231]
    v_add_u32 v9, 4096, v9
    global_load_dwordx4 v[100:103], v9, s[20:21] offset:0 sc1
    s_waitcnt vmcnt(23)
    v_mfma_f32_16x16x32_bf16 v[184:187], a[112:115], v[24:27], v[184:187]
    v_mfma_f32_16x16x32_bf16 v[200:203], a[116:119], v[24:27], v[200:203]
    v_mfma_f32_16x16x32_bf16 v[216:219], a[120:123], v[24:27], v[216:219]
    v_mfma_f32_16x16x32_bf16 v[232:235], a[124:127], v[24:27], v[232:235]
    v_add_u32 v10, 4096, v10
    global_load_dwordx4 v[104:107], v10, s[20:21] offset:0 sc1
    s_waitcnt vmcnt(23)
    v_mfma_f32_16x16x32_bf16 v[188:191], a[112:115], v[28:31], v[188:191]
    v_mfma_f32_16x16x32_bf16 v[204:207], a[116:119], v[28:31], v[204:207]
    v_mfma_f32_16x16x32_bf16 v[220:223], a[120:123], v[28:31], v[220:223]
    v_mfma_f32_16x16x32_bf16 v[236:239], a[124:127], v[28:31], v[236:239]
    v_add_u32 v11, 4096, v11
    global_load_dwordx4 v[108:111], v11, s[20:21] offset:0 sc1
    s_waitcnt vmcnt(23)
    v_mfma_f32_16x16x32_bf16 v[176:179], a[128:131], v[32:35], v[176:179]
    v_mfma_f32_16x16x32_bf16 v[192:195], a[132:135], v[32:35], v[192:195]
    v_mfma_f32_16x16x32_bf16 v[208:211], a[136:139], v[32:35], v[208:211]
    v_mfma_f32_16x16x32_bf16 v[224:227], a[140:143], v[32:35], v[224:227]
    global_load_dwordx4 v[112:115], v8, s[20:21] offset:1024 sc1
    s_waitcnt vmcnt(23)
    v_mfma_f32_16x16x32_bf16 v[180:183], a[128:131], v[36:39], v[180:183]
    v_mfma_f32_16x16x32_bf16 v[196:199], a[132:135], v[36:39], v[196:199]
    v_mfma_f32_16x16x32_bf16 v[212:215], a[136:139], v[36:39], v[212:215]
    v_mfma_f32_16x16x32_bf16 v[228:231], a[140:143], v[36:39], v[228:231]
    global_load_dwordx4 v[116:119], v9, s[20:21] offset:1024 sc1
    s_waitcnt vmcnt(23)
    v_mfma_f32_16x16x32_bf16 v[184:187], a[128:131], v[40:43], v[184:187]
    v_mfma_f32_16x16x32_bf16 v[200:203], a[132:135], v[40:43], v[200:203]
    v_mfma_f32_16x16x32_bf16 v[216:219], a[136:139], v[40:43], v[216:219]
    v_mfma_f32_16x16x32_bf16 v[232:235], a[140:143], v[40:43], v[232:235]
    global_load_dwordx4 v[120:123], v10, s[20:21] offset:1024 sc1
    s_waitcnt vmcnt(23)
    v_mfma_f32_16x16x32_bf16 v[188:191], a[128:131], v[44:47], v[188:191]
    v_mfma_f32_16x16x32_bf16 v[204:207], a[132:135], v[44:47], v[204:207]
    v_mfma_f32_16x16x32_bf16 v[220:223], a[136:139], v[44:47], v[220:223]
    v_mfma_f32_16x16x32_bf16 v[236:239], a[140:143], v[44:47], v[236:239]
    global_load_dwordx4 v[124:127], v11, s[20:21] offset:1024 sc1
    s_waitcnt vmcnt(23)
    v_mfma_f32_16x16x32_bf16 v[176:179], a[144:147], v[48:51], v[176:179]
    v_mfma_f32_16x16x32_bf16 v[192:195], a[148:151], v[48:51], v[192:195]
    v_mfma_f32_16x16x32_bf16 v[208:211], a[152:155], v[48:51], v[208:211]
    v_mfma_f32_16x16x32_bf16 v[224:227], a[156:159], v[48:51], v[224:227]
    s_waitcnt vmcnt(22)
    v_mfma_f32_16x16x32_bf16 v[180:183], a[144:147], v[52:55], v[180:183]
    v_mfma_f32_16x16x32_bf16 v[196:199], a[148:151], v[52:55], v[196:199]
    v_mfma_f32_16x16x32_bf16 v[212:215], a[152:155], v[52:55], v[212:215]
    v_mfma_f32_16x16x32_bf16 v[228:231], a[156:159], v[52:55], v[228:231]
    s_waitcnt vmcnt(21)
    v_mfma_f32_16x16x32_bf16 v[184:187], a[144:147], v[56:59], v[184:187]
    v_mfma_f32_16x16x32_bf16 v[200:203], a[148:151], v[56:59], v[200:203]
    v_mfma_f32_16x16x32_bf16 v[216:219], a[152:155], v[56:59], v[216:219]
    v_mfma_f32_16x16x32_bf16 v[232:235], a[156:159], v[56:59], v[232:235]
    s_waitcnt vmcnt(20)
    v_mfma_f32_16x16x32_bf16 v[188:191], a[144:147], v[60:63], v[188:191]
    v_mfma_f32_16x16x32_bf16 v[204:207], a[148:151], v[60:63], v[204:207]
    v_mfma_f32_16x16x32_bf16 v[220:223], a[152:155], v[60:63], v[220:223]
    v_mfma_f32_16x16x32_bf16 v[236:239], a[156:159], v[60:63], v[236:239]
    s_waitcnt vmcnt(18)
    v_mfma_f32_16x16x32_bf16 v[176:179], a[160:163], v[64:67], v[176:179]
    v_mfma_f32_16x16x32_bf16 v[192:195], a[164:167], v[64:67], v[192:195]
    v_mfma_f32_16x16x32_bf16 v[208:211], a[168:171], v[64:67], v[208:211]
    v_mfma_f32_16x16x32_bf16 v[224:227], a[172:175], v[64:67], v[224:227]
    s_waitcnt vmcnt(16)
    v_mfma_f32_16x16x32_bf16 v[180:183], a[160:163], v[68:71], v[180:183]
    v_mfma_f32_16x16x32_bf16 v[196:199], a[164:167], v[68:71], v[196:199]
    v_mfma_f32_16x16x32_bf16 v[212:215], a[168:171], v[68:71], v[212:215]
    v_mfma_f32_16x16x32_bf16 v[228:231], a[172:175], v[68:71], v[228:231]
    s_waitcnt vmcnt(14)
    v_mfma_f32_16x16x32_bf16 v[184:187], a[160:163], v[72:75], v[184:187]
    v_mfma_f32_16x16x32_bf16 v[200:203], a[164:167], v[72:75], v[200:203]
    v_mfma_f32_16x16x32_bf16 v[216:219], a[168:171], v[72:75], v[216:219]
    v_mfma_f32_16x16x32_bf16 v[232:235], a[172:175], v[72:75], v[232:235]
    s_waitcnt vmcnt(12)
    v_mfma_f32_16x16x32_bf16 v[188:191], a[160:163], v[76:79], v[188:191]
    v_mfma_f32_16x16x32_bf16 v[204:207], a[164:167], v[76:79], v[204:207]
    v_mfma_f32_16x16x32_bf16 v[220:223], a[168:171], v[76:79], v[220:223]
    v_mfma_f32_16x16x32_bf16 v[236:239], a[172:175], v[76:79], v[236:239]
    s_waitcnt vmcnt(11)
    v_mfma_f32_16x16x32_bf16 v[176:179], a[176:179], v[80:83], v[176:179]
    v_mfma_f32_16x16x32_bf16 v[192:195], a[180:183], v[80:83], v[192:195]
    v_mfma_f32_16x16x32_bf16 v[208:211], a[184:187], v[80:83], v[208:211]
    v_mfma_f32_16x16x32_bf16 v[224:227], a[188:191], v[80:83], v[224:227]
    s_waitcnt vmcnt(10)
    v_mfma_f32_16x16x32_bf16 v[180:183], a[176:179], v[84:87], v[180:183]
    v_mfma_f32_16x16x32_bf16 v[196:199], a[180:183], v[84:87], v[196:199]
    v_mfma_f32_16x16x32_bf16 v[212:215], a[184:187], v[84:87], v[212:215]
    v_mfma_f32_16x16x32_bf16 v[228:231], a[188:191], v[84:87], v[228:231]
    s_waitcnt vmcnt(9)
    v_mfma_f32_16x16x32_bf16 v[184:187], a[176:179], v[88:91], v[184:187]
    v_mfma_f32_16x16x32_bf16 v[200:203], a[180:183], v[88:91], v[200:203]
    v_mfma_f32_16x16x32_bf16 v[216:219], a[184:187], v[88:91], v[216:219]
    v_mfma_f32_16x16x32_bf16 v[232:235], a[188:191], v[88:91], v[232:235]
    s_waitcnt vmcnt(8)
    v_mfma_f32_16x16x32_bf16 v[188:191], a[176:179], v[92:95], v[188:191]
    v_mfma_f32_16x16x32_bf16 v[204:207], a[180:183], v[92:95], v[204:207]
    v_mfma_f32_16x16x32_bf16 v[220:223], a[184:187], v[92:95], v[220:223]
    v_mfma_f32_16x16x32_bf16 v[236:239], a[188:191], v[92:95], v[236:239]
    s_waitcnt vmcnt(7)
    v_mfma_f32_16x16x32_bf16 v[176:179], a[192:195], v[96:99], v[176:179]
    v_mfma_f32_16x16x32_bf16 v[192:195], a[196:199], v[96:99], v[192:195]
    v_mfma_f32_16x16x32_bf16 v[208:211], a[200:203], v[96:99], v[208:211]
    v_mfma_f32_16x16x32_bf16 v[224:227], a[204:207], v[96:99], v[224:227]
    s_waitcnt vmcnt(6)
    v_mfma_f32_16x16x32_bf16 v[180:183], a[192:195], v[100:103], v[180:183]
    v_mfma_f32_16x16x32_bf16 v[196:199], a[196:199], v[100:103], v[196:199]
    v_mfma_f32_16x16x32_bf16 v[212:215], a[200:203], v[100:103], v[212:215]
    v_mfma_f32_16x16x32_bf16 v[228:231], a[204:207], v[100:103], v[228:231]
    s_waitcnt vmcnt(5)
    v_mfma_f32_16x16x32_bf16 v[184:187], a[192:195], v[104:107], v[184:187]
    v_mfma_f32_16x16x32_bf16 v[200:203], a[196:199], v[104:107], v[200:203]
    v_mfma_f32_16x16x32_bf16 v[216:219], a[200:203], v[104:107], v[216:219]
    v_mfma_f32_16x16x32_bf16 v[232:235], a[204:207], v[104:107], v[232:235]
    s_waitcnt vmcnt(4)
    v_mfma_f32_16x16x32_bf16 v[188:191], a[192:195], v[108:111], v[188:191]
    v_mfma_f32_16x16x32_bf16 v[204:207], a[196:199], v[108:111], v[204:207]
    v_mfma_f32_16x16x32_bf16 v[220:223], a[200:203], v[108:111], v[220:223]
    v_mfma_f32_16x16x32_bf16 v[236:239], a[204:207], v[108:111], v[236:239]
    s_waitcnt vmcnt(3)
    v_mfma_f32_16x16x32_bf16 v[176:179], a[208:211], v[112:115], v[176:179]
    v_mfma_f32_16x16x32_bf16 v[192:195], a[212:215], v[112:115], v[192:195]
    v_mfma_f32_16x16x32_bf16 v[208:211], a[216:219], v[112:115], v[208:211]
    v_mfma_f32_16x16x32_bf16 v[224:227], a[220:223], v[112:115], v[224:227]
    s_waitcnt vmcnt(2)
    v_mfma_f32_16x16x32_bf16 v[180:183], a[208:211], v[116:119], v[180:183]
    v_mfma_f32_16x16x32_bf16 v[196:199], a[212:215], v[116:119], v[196:199]
    v_mfma_f32_16x16x32_bf16 v[212:215], a[216:219], v[116:119], v[212:215]
    v_mfma_f32_16x16x32_bf16 v[228:231], a[220:223], v[116:119], v[228:231]
    s_waitcnt vmcnt(1)
    v_mfma_f32_16x16x32_bf16 v[184:187], a[208:211], v[120:123], v[184:187]
    v_mfma_f32_16x16x32_bf16 v[200:203], a[212:215], v[120:123], v[200:203]
    v_mfma_f32_16x16x32_bf16 v[216:219], a[216:219], v[120:123], v[216:219]
    v_mfma_f32_16x16x32_bf16 v[232:235], a[220:223], v[120:123], v[232:235]
    s_waitcnt vmcnt(0)
    v_mfma_f32_16x16x32_bf16 v[188:191], a[208:211], v[124:127], v[188:191]
    v_mfma_f32_16x16x32_bf16 v[204:207], a[212:215], v[124:127], v[204:207]
    v_mfma_f32_16x16x32_bf16 v[220:223], a[216:219], v[124:127], v[220:223]
    v_mfma_f32_16x16x32_bf16 v[236:239], a[220:223], v[124:127], v[236:239]
    s_mul_i32 s45, s22, 12288
    v_add_u32 v15, s45, v5
    v_bfe_u32 v8, v2, 2, 2
    v_lshl_add_u32 v8, v4, 2, v8
    v_lshlrev_b32 v8, 6, v8
    v_and_b32 v9, 3, v2
    v_lshlrev_b32 v9, 3, v9
    v_add3_u32 v8, v8, v9, s61
    ds_read_b64_tr_b16 v[16:17], v8 offset:0
    ds_read_b64_tr_b16 v[18:19], v8 offset:32
    ds_read_b64_tr_b16 v[20:21], v8 offset:1024
    ds_read_b64_tr_b16 v[22:23], v8 offset:1056
    s_cmp_eq_u32 s22, 0
    s_cbranch_scc0 sequential_preLN__ssm_conv_s4__mixer_channel_mlp__prompt_kernel_r0
    ds_write_b128 v15, v[192:195] offset:0
    ds_write_b128 v15, v[196:199] offset:1024
    ds_write_b128 v15, v[200:203] offset:2048
    ds_write_b128 v15, v[204:207] offset:3072
    ds_write_b128 v15, v[208:211] offset:4096
    ds_write_b128 v15, v[212:215] offset:5120
    ds_write_b128 v15, v[216:219] offset:6144
    ds_write_b128 v15, v[220:223] offset:7168
    ds_write_b128 v15, v[224:227] offset:8192
    ds_write_b128 v15, v[228:231] offset:9216
    ds_write_b128 v15, v[232:235] offset:10240
    ds_write_b128 v15, v[236:239] offset:11264
    s_waitcnt lgkmcnt(0)
    s_barrier
    ds_read_b128 v[32:35], v5 offset:20480
    ds_read_b128 v[36:39], v5 offset:21504
    ds_read_b128 v[40:43], v5 offset:22528
    ds_read_b128 v[44:47], v5 offset:23552
    ds_read_b128 v[48:51], v5 offset:28672
    ds_read_b128 v[52:55], v5 offset:29696
    ds_read_b128 v[56:59], v5 offset:30720
    ds_read_b128 v[60:63], v5 offset:31744
    ds_read_b128 v[64:67], v5 offset:36864
    ds_read_b128 v[68:71], v5 offset:37888
    ds_read_b128 v[72:75], v5 offset:38912
    ds_read_b128 v[76:79], v5 offset:39936
    s_branch sequential_preLN__ssm_conv_s4__mixer_channel_mlp__prompt_kernel_fin
sequential_preLN__ssm_conv_s4__mixer_channel_mlp__prompt_kernel_r0:
    s_cmp_eq_u32 s22, 1
    s_cbranch_scc0 sequential_preLN__ssm_conv_s4__mixer_channel_mlp__prompt_kernel_r1
    ds_write_b128 v15, v[208:211] offset:0
    ds_write_b128 v15, v[212:215] offset:1024
    ds_write_b128 v15, v[216:219] offset:2048
    ds_write_b128 v15, v[220:223] offset:3072
    ds_write_b128 v15, v[224:227] offset:4096
    ds_write_b128 v15, v[228:231] offset:5120
    ds_write_b128 v15, v[232:235] offset:6144
    ds_write_b128 v15, v[236:239] offset:7168
    ds_write_b128 v15, v[176:179] offset:8192
    ds_write_b128 v15, v[180:183] offset:9216
    ds_write_b128 v15, v[184:187] offset:10240
    ds_write_b128 v15, v[188:191] offset:11264
    v_pk_mul_f32 v[176:177], v[192:193], 1.0 op_sel_hi:[1,0]
    v_pk_mul_f32 v[178:179], v[194:195], 1.0 op_sel_hi:[1,0]
    v_pk_mul_f32 v[180:181], v[196:197], 1.0 op_sel_hi:[1,0]
    v_pk_mul_f32 v[182:183], v[198:199], 1.0 op_sel_hi:[1,0]
    v_pk_mul_f32 v[184:185], v[200:201], 1.0 op_sel_hi:[1,0]
    v_pk_mul_f32 v[186:187], v[202:203], 1.0 op_sel_hi:[1,0]
    v_pk_mul_f32 v[188:189], v[204:205], 1.0 op_sel_hi:[1,0]
    v_pk_mul_f32 v[190:191], v[206:207], 1.0 op_sel_hi:[1,0]
    s_waitcnt lgkmcnt(0)
    s_barrier
    ds_read_b128 v[32:35], v5 offset:32768
    ds_read_b128 v[36:39], v5 offset:33792
    ds_read_b128 v[40:43], v5 offset:34816
    ds_read_b128 v[44:47], v5 offset:35840
    ds_read_b128 v[48:51], v5 offset:40960
    ds_read_b128 v[52:55], v5 offset:41984
    ds_read_b128 v[56:59], v5 offset:43008
    ds_read_b128 v[60:63], v5 offset:44032
    ds_read_b128 v[64:67], v5 offset:0
    ds_read_b128 v[68:71], v5 offset:1024
    ds_read_b128 v[72:75], v5 offset:2048
    ds_read_b128 v[76:79], v5 offset:3072
    s_branch sequential_preLN__ssm_conv_s4__mixer_channel_mlp__prompt_kernel_fin
sequential_preLN__ssm_conv_s4__mixer_channel_mlp__prompt_kernel_r1:
    s_cmp_eq_u32 s22, 2
    s_cbranch_scc0 sequential_preLN__ssm_conv_s4__mixer_channel_mlp__prompt_kernel_r2
    ds_write_b128 v15, v[224:227] offset:0
    ds_write_b128 v15, v[228:231] offset:1024
    ds_write_b128 v15, v[232:235] offset:2048
    ds_write_b128 v15, v[236:239] offset:3072
    ds_write_b128 v15, v[176:179] offset:4096
    ds_write_b128 v15, v[180:183] offset:5120
    ds_write_b128 v15, v[184:187] offset:6144
    ds_write_b128 v15, v[188:191] offset:7168
    ds_write_b128 v15, v[192:195] offset:8192
    ds_write_b128 v15, v[196:199] offset:9216
    ds_write_b128 v15, v[200:203] offset:10240
    ds_write_b128 v15, v[204:207] offset:11264
    v_pk_mul_f32 v[176:177], v[208:209], 1.0 op_sel_hi:[1,0]
    v_pk_mul_f32 v[178:179], v[210:211], 1.0 op_sel_hi:[1,0]
    v_pk_mul_f32 v[180:181], v[212:213], 1.0 op_sel_hi:[1,0]
    v_pk_mul_f32 v[182:183], v[214:215], 1.0 op_sel_hi:[1,0]
    v_pk_mul_f32 v[184:185], v[216:217], 1.0 op_sel_hi:[1,0]
    v_pk_mul_f32 v[186:187], v[218:219], 1.0 op_sel_hi:[1,0]
    v_pk_mul_f32 v[188:189], v[220:221], 1.0 op_sel_hi:[1,0]
    v_pk_mul_f32 v[190:191], v[222:223], 1.0 op_sel_hi:[1,0]
    s_waitcnt lgkmcnt(0)
    s_barrier
    ds_read_b128 v[32:35], v5 offset:45056
    ds_read_b128 v[36:39], v5 offset:46080
    ds_read_b128 v[40:43], v5 offset:47104
    ds_read_b128 v[44:47], v5 offset:48128
    ds_read_b128 v[48:51], v5 offset:4096
    ds_read_b128 v[52:55], v5 offset:5120
    ds_read_b128 v[56:59], v5 offset:6144
    ds_read_b128 v[60:63], v5 offset:7168
    ds_read_b128 v[64:67], v5 offset:12288
    ds_read_b128 v[68:71], v5 offset:13312
    ds_read_b128 v[72:75], v5 offset:14336
    ds_read_b128 v[76:79], v5 offset:15360
    s_branch sequential_preLN__ssm_conv_s4__mixer_channel_mlp__prompt_kernel_fin
sequential_preLN__ssm_conv_s4__mixer_channel_mlp__prompt_kernel_r2:
    s_cmp_eq_u32 s22, 3
    s_cbranch_scc0 sequential_preLN__ssm_conv_s4__mixer_channel_mlp__prompt_kernel_r3
    ds_write_b128 v15, v[176:179] offset:0
    ds_write_b128 v15, v[180:183] offset:1024
    ds_write_b128 v15, v[184:187] offset:2048
    ds_write_b128 v15, v[188:191] offset:3072
    ds_write_b128 v15, v[192:195] offset:4096
    ds_write_b128 v15, v[196:199] offset:5120
    ds_write_b128 v15, v[200:203] offset:6144
    ds_write_b128 v15, v[204:207] offset:7168
    ds_write_b128 v15, v[208:211] offset:8192
    ds_write_b128 v15, v[212:215] offset:9216
    ds_write_b128 v15, v[216:219] offset:10240
    ds_write_b128 v15, v[220:223] offset:11264
    v_pk_mul_f32 v[176:177], v[224:225], 1.0 op_sel_hi:[1,0]
    v_pk_mul_f32 v[178:179], v[226:227], 1.0 op_sel_hi:[1,0]
    v_pk_mul_f32 v[180:181], v[228:229], 1.0 op_sel_hi:[1,0]
    v_pk_mul_f32 v[182:183], v[230:231], 1.0 op_sel_hi:[1,0]
    v_pk_mul_f32 v[184:185], v[232:233], 1.0 op_sel_hi:[1,0]
    v_pk_mul_f32 v[186:187], v[234:235], 1.0 op_sel_hi:[1,0]
    v_pk_mul_f32 v[188:189], v[236:237], 1.0 op_sel_hi:[1,0]
    v_pk_mul_f32 v[190:191], v[238:239], 1.0 op_sel_hi:[1,0]
    s_waitcnt lgkmcnt(0)
    s_barrier
    ds_read_b128 v[32:35], v5 offset:8192
    ds_read_b128 v[36:39], v5 offset:9216
    ds_read_b128 v[40:43], v5 offset:10240
    ds_read_b128 v[44:47], v5 offset:11264
    ds_read_b128 v[48:51], v5 offset:16384
    ds_read_b128 v[52:55], v5 offset:17408
    ds_read_b128 v[56:59], v5 offset:18432
    ds_read_b128 v[60:63], v5 offset:19456
    ds_read_b128 v[64:67], v5 offset:24576
    ds_read_b128 v[68:71], v5 offset:25600
    ds_read_b128 v[72:75], v5 offset:26624
    ds_read_b128 v[76:79], v5 offset:27648
    s_branch sequential_preLN__ssm_conv_s4__mixer_channel_mlp__prompt_kernel_fin
sequential_preLN__ssm_conv_s4__mixer_channel_mlp__prompt_kernel_r3:
sequential_preLN__ssm_conv_s4__mixer_channel_mlp__prompt_kernel_fin:
    v_lshlrev_b32 v24, 16, v12
    v_and_b32 v25, 0xffff0000, v12
    v_lshlrev_b32 v26, 16, v13
    v_and_b32 v27, 0xffff0000, v13
    v_lshlrev_b32 v96, 16, v16
    v_and_b32 v97, 0xffff0000, v16
    v_lshlrev_b32 v98, 16, v17
    v_and_b32 v99, 0xffff0000, v17
    v_lshlrev_b32 v100, 16, v18
    v_and_b32 v101, 0xffff0000, v18
    v_lshlrev_b32 v102, 16, v19
    v_and_b32 v103, 0xffff0000, v19
    v_lshlrev_b32 v104, 16, v20
    v_and_b32 v105, 0xffff0000, v20
    v_lshlrev_b32 v106, 16, v21
    v_and_b32 v107, 0xffff0000, v21
    v_lshlrev_b32 v108, 16, v22
    v_and_b32 v109, 0xffff0000, v22
    v_lshlrev_b32 v110, 16, v23
    v_and_b32 v111, 0xffff0000, v23
    s_waitcnt lgkmcnt(0)
    v_pk_add_f32 v[176:177], v[176:177], v[32:33]
    v_pk_add_f32 v[178:179], v[178:179], v[34:35]
    v_pk_add_f32 v[180:181], v[180:181], v[36:37]
    v_pk_add_f32 v[182:183], v[182:183], v[38:39]
    v_pk_add_f32 v[184:185], v[184:185], v[40:41]
    v_pk_add_f32 v[186:187], v[186:187], v[42:43]
    v_pk_add_f32 v[188:189], v[188:189], v[44:45]
    v_pk_add_f32 v[190:191], v[190:191], v[46:47]
    v_pk_add_f32 v[176:177], v[176:177], v[48:49]
    v_pk_add_f32 v[178:179], v[178:179], v[50:51]
    v_pk_add_f32 v[180:181], v[180:181], v[52:53]
    v_pk_add_f32 v[182:183], v[182:183], v[54:55]
    v_pk_add_f32 v[184:185], v[184:185], v[56:57]
    v_pk_add_f32 v[186:187], v[186:187], v[58:59]
    v_pk_add_f32 v[188:189], v[188:189], v[60:61]
    v_pk_add_f32 v[190:191], v[190:191], v[62:63]
    v_pk_add_f32 v[176:177], v[176:177], v[64:65]
    v_pk_add_f32 v[178:179], v[178:179], v[66:67]
    v_pk_add_f32 v[180:181], v[180:181], v[68:69]
    v_pk_add_f32 v[182:183], v[182:183], v[70:71]
    v_pk_add_f32 v[184:185], v[184:185], v[72:73]
    v_pk_add_f32 v[186:187], v[186:187], v[74:75]
    v_pk_add_f32 v[188:189], v[188:189], v[76:77]
    v_pk_add_f32 v[190:191], v[190:191], v[78:79]
    v_cvt_pk_bf16_f32 v112, v176, v177
    v_cvt_pk_bf16_f32 v113, v178, v179
    v_cvt_pk_bf16_f32 v114, v180, v181
    v_cvt_pk_bf16_f32 v115, v182, v183
    v_cvt_pk_bf16_f32 v116, v184, v185
    v_cvt_pk_bf16_f32 v117, v186, v187
    v_cvt_pk_bf16_f32 v118, v188, v189
    v_cvt_pk_bf16_f32 v119, v190, v191
    v_lshlrev_b32 v176, 16, v112
    v_and_b32 v177, 0xffff0000, v112
    v_lshlrev_b32 v178, 16, v113
    v_and_b32 v179, 0xffff0000, v113
    v_lshlrev_b32 v180, 16, v114
    v_and_b32 v181, 0xffff0000, v114
    v_lshlrev_b32 v182, 16, v115
    v_and_b32 v183, 0xffff0000, v115
    v_lshlrev_b32 v184, 16, v116
    v_and_b32 v185, 0xffff0000, v116
    v_lshlrev_b32 v186, 16, v117
    v_and_b32 v187, 0xffff0000, v117
    v_lshlrev_b32 v188, 16, v118
    v_and_b32 v189, 0xffff0000, v118
    v_lshlrev_b32 v190, 16, v119
    v_and_b32 v191, 0xffff0000, v119
    v_pk_add_f32 v[176:177], v[176:177], v[24:25]
    v_pk_add_f32 v[178:179], v[178:179], v[26:27]
    v_pk_add_f32 v[180:181], v[180:181], v[24:25]
    v_pk_add_f32 v[182:183], v[182:183], v[26:27]
    v_pk_add_f32 v[184:185], v[184:185], v[24:25]
    v_pk_add_f32 v[186:187], v[186:187], v[26:27]
    v_pk_add_f32 v[188:189], v[188:189], v[24:25]
    v_pk_add_f32 v[190:191], v[190:191], v[26:27]
    v_cvt_pk_bf16_f32 v112, v176, v177
    v_cvt_pk_bf16_f32 v113, v178, v179
    v_cvt_pk_bf16_f32 v114, v180, v181
    v_cvt_pk_bf16_f32 v115, v182, v183
    v_cvt_pk_bf16_f32 v116, v184, v185
    v_cvt_pk_bf16_f32 v117, v186, v187
    v_cvt_pk_bf16_f32 v118, v188, v189
    v_cvt_pk_bf16_f32 v119, v190, v191
    v_lshlrev_b32 v176, 16, v112
    v_and_b32 v177, 0xffff0000, v112
    v_lshlrev_b32 v178, 16, v113
    v_and_b32 v179, 0xffff0000, v113
    v_lshlrev_b32 v180, 16, v114
    v_and_b32 v181, 0xffff0000, v114
    v_lshlrev_b32 v182, 16, v115
    v_and_b32 v183, 0xffff0000, v115
    v_lshlrev_b32 v184, 16, v116
    v_and_b32 v185, 0xffff0000, v116
    v_lshlrev_b32 v186, 16, v117
    v_and_b32 v187, 0xffff0000, v117
    v_lshlrev_b32 v188, 16, v118
    v_and_b32 v189, 0xffff0000, v118
    v_lshlrev_b32 v190, 16, v119
    v_and_b32 v191, 0xffff0000, v119
    v_pk_add_f32 v[176:177], v[176:177], v[96:97]
    v_pk_add_f32 v[178:179], v[178:179], v[98:99]
    v_pk_add_f32 v[180:181], v[180:181], v[100:101]
    v_pk_add_f32 v[182:183], v[182:183], v[102:103]
    v_pk_add_f32 v[184:185], v[184:185], v[104:105]
    v_pk_add_f32 v[186:187], v[186:187], v[106:107]
    v_pk_add_f32 v[188:189], v[188:189], v[108:109]
    v_pk_add_f32 v[190:191], v[190:191], v[110:111]
    v_cvt_pk_bf16_f32 v112, v176, v177
    v_cvt_pk_bf16_f32 v113, v178, v179
    v_add_u32 v9, 0, v14
    global_store_dwordx2 v9, v[112:113], s[36:37]
    v_cvt_pk_bf16_f32 v114, v180, v181
    v_cvt_pk_bf16_f32 v115, v182, v183
    v_add_u32 v9, 16384, v14
    global_store_dwordx2 v9, v[114:115], s[36:37]
    v_cvt_pk_bf16_f32 v116, v184, v185
    v_cvt_pk_bf16_f32 v117, v186, v187
    v_add_u32 v9, 32768, v14
    global_store_dwordx2 v9, v[116:117], s[36:37]
    v_cvt_pk_bf16_f32 v118, v188, v189
    v_cvt_pk_bf16_f32 v119, v190, v191
    v_add_u32 v9, 49152, v14
    global_store_dwordx2 v9, v[118:119], s[36:37]
sequential_preLN__ssm_conv_s4__mixer_channel_mlp__prompt_kernel_end:
    s_endpgm
.p2align 8
.type sequential_preLN__ssm_conv_s4__mixer_channel_mlp__prompt_kernel_tbl,@object
sequential_preLN__ssm_conv_s4__mixer_channel_mlp__prompt_kernel_tbl:
.long 0xeb90eb90, 0xeb90eb90, 0xeb88eb88, 0xeb88eb88, 0xeb88, 0xe144e140, 0xe14ce148, 0xea04e980, 0xeb0cea88, 0x0, 0x3880, 0x7e20, 0xb6a0, 0xfc40, 0x134c0, 0x17a60
.long 0xeb88eb88, 0xeb84eb88, 0xeb84eb84, 0xeb84eb84, 0xeb84, 0xe164e160, 0xe16ce168, 0xea08e984, 0xeb10ea8c, 0x10, 0x3890, 0x7e30, 0xb6b0, 0xfc50, 0x134d0, 0x17a70
.long 0xeb84eb84, 0xeb84eb84, 0xeb80eb80, 0xeb80eb80, 0xeb80, 0xe184e180, 0xe18ce188, 0xea0ce988, 0xeb14ea90, 0x20, 0x38a0, 0x7e40, 0xb6c0, 0xfc60, 0x14200, 0x17a80
.long 0xeb80eb80, 0xeb7ceb80, 0xeb7ceb7c, 0xeb7ceb7c, 0xeb7c, 0xe1a4e1a0, 0xe1ace1a8, 0xea10e98c, 0xeb18ea94, 0x30, 0x38b0, 0x7e50, 0xb6d0, 0xfc70, 0x14210, 0x17a90
.long 0xeb7ceb7c, 0xeb7ceb7c, 0xeb78eb78, 0xeb78eb78, 0xeb78, 0xe1c8e1c4, 0xe1d0e1cc, 0xea14e990, 0xeb1cea98, 0x40, 0x38c0, 0x7e60, 0xc400, 0xfc80, 0x14220, 0x17aa0
.long 0xeb78eb78, 0xeb74eb78, 0xeb74eb74, 0xeb74eb74, 0xeb74, 0xe1e8e1e4, 0xe1f0e1ec, 0xea18e994, 0xeb20ea9c, 0x50, 0x38d0, 0x7e70, 0xc410, 0xfc90, 0x14230, 0x17ab0
.long 0xeb74eb74, 0xeb74eb74, 0xeb70eb70, 0xeb70eb70, 0xeb70, 0xe208e204, 0xe210e20c, 0xea1ce998, 0xeb24eaa0, 0x60, 0x4600, 0x7e80, 0xc420, 0xfca0, 0x14240, 0x17ac0
.long 0xeb70eb70, 0xeb6ceb70, 0xeb6ceb6c, 0xeb6ceb6c, 0xeb6c, 0xe228e224, 0xe230e22c, 0xea20e99c, 0xeb28eaa4, 0x70, 0x4610, 0x7e90, 0xc430, 0xfcb0, 0x14250, 0x17ad0
.long 0xeb6ceb6c, 0xeb6ceb6c, 0xeb68eb68, 0xeb68eb68, 0xeb68, 0xe24ce248, 0xe254e250, 0xea24e9a0, 0xeb2ceaa8, 0x80, 0x4620, 0x7ea0, 0xc440, 0xfcc0, 0x14260, 0x18800
.long 0xeb68eb68, 0xeb64eb68, 0xeb64eb64, 0xeb64eb64, 0xeb64, 0xe26ce268, 0xe274e270, 0xea28e9a4, 0xeb30eaac, 0x90, 0x4630, 0x7eb0, 0xc450, 0xfcd0, 0x14270, 0x18810
.long 0xeb64eb64, 0xeb64eb64, 0xeb60eb60, 0xeb60eb60, 0xeb60, 0xe28ce288, 0xe294e290, 0xea2ce9a8, 0xeb34eab0, 0xa0, 0x4640, 0x7ec0, 0xc460, 0x10a00, 0x14280, 0x18820
.long 0xeb60eb60, 0xeb5ceb60, 0xeb5ceb5c, 0xeb5ceb5c, 0xeb5c, 0xe2ace2a8, 0xe2b4e2b0, 0xea30e9ac, 0xeb38eab4, 0xb0, 0x4650, 0x7ed0, 0xc470, 0x10a10, 0x14290, 0x18830
.long 0xeb5ceb5c, 0xeb5ceb5c, 0xeb58eb58, 0xeb58eb58, 0xeb58, 0xe2d0e2cc, 0xe2d8e2d4, 0xea34e9b0, 0xeb3ceab8, 0xc0, 0x4660, 0x8c00, 0xc480, 0x10a20, 0x142a0, 0x18840
.long 0xeb58eb58, 0xeb54eb58, 0xeb54eb54, 0xeb54eb54, 0xeb54, 0xe2f0e2ec, 0xe2f8e2f4, 0xea38e9b4, 0xeb40eabc, 0xd0, 0x4670, 0x8c10, 0xc490, 0x10a30, 0x142b0, 0x18850
.long 0xeb54eb54, 0xeb54eb54, 0xeb50eb50, 0xeb50eb50, 0xeb50, 0xe310e30c, 0xe318e314, 0xea3ce9b8, 0xeb44eac0, 0xe00, 0x4680, 0x8c20, 0xc4a0, 0x10a40, 0x142c0, 0x18860
.long 0xeb50eb50, 0xeb4ceb50, 0xeb4ceb4c, 0xeb4ceb4c, 0xeb4c, 0xe330e32c, 0xe338e334, 0xea40e9bc, 0xeb48eac4, 0xe10, 0x4690, 0x8c30, 0xc4b0, 0x10a50, 0x142d0, 0x18870
.long 0xeb4ceb4c, 0xeb4ceb4c, 0xeb48eb48, 0xeb48eb48, 0xeb48, 0xe154e150, 0xe15ce158, 0xec14eb90, 0xec14ec14, 0xe20, 0x46a0, 0x8c40, 0xc4c0, 0x10a60, 0x15000, 0x18880
.long 0xeb48eb48, 0xeb44eb48, 0xeb44eb44, 0xeb44eb44, 0xeb44, 0xe174e170, 0xe17ce178, 0xec18eb94, 0xec18ec18, 0xe30, 0x46b0, 0x8c50, 0xc4d0, 0x10a70, 0x15010, 0x18890
.long 0xeb44eb44, 0xeb44eb44, 0xeb40eb40, 0xeb40eb40, 0xeb40, 0xe194e190, 0xe19ce198, 0xec1ceb98, 0xec1cec1c, 0xe40, 0x46c0, 0x8c60, 0xd200, 0x10a80, 0x15020, 0x188a0
.long 0xeb40eb40, 0xeb3ceb40, 0xeb3ceb3c, 0xeb3ceb3c, 0xeb3c, 0xe1b4e1b0, 0xe1bce1b8, 0xec20eb9c, 0xec20ec20, 0xe50, 0x46d0, 0x8c70, 0xd210, 0x10a90, 0x15030, 0x188b0
.long 0xeb3ceb3c, 0xeb3ceb3c, 0xeb38eb38, 0xeb38eb38, 0xeb38, 0xe1d8e1d4, 0xe1e0e1dc, 0xec24eba0, 0xec24ec24, 0xe60, 0x5400, 0x8c80, 0xd220, 0x10aa0, 0x15040, 0x188c0
.long 0xeb38eb38, 0xeb34eb38, 0xeb34eb34, 0xeb34eb34, 0xeb34, 0xe1f8e1f4, 0xe200e1fc, 0xec28eba4, 0xec28ec28, 0xe70, 0x5410, 0x8c90, 0xd230, 0x10ab0, 0x15050, 0x188d0
.long 0xeb34eb34, 0xeb34eb34, 0xeb30eb30, 0xeb30eb30, 0xeb30, 0xe218e214, 0xe220e21c, 0xec2ceba8, 0xec2cec2c, 0xe80, 0x5420, 0x8ca0, 0xd240, 0x10ac0, 0x15060, 0x19600
.long 0xeb30eb30, 0xeb2ceb30, 0xeb2ceb2c, 0xeb2ceb2c, 0xeb2c, 0xe238e234, 0xe240e23c, 0xec30ebac, 0xec30ec30, 0xe90, 0x5430, 0x8cb0, 0xd250, 0x10ad0, 0x15070, 0x19610
.long 0xeb2ceb2c, 0xeb2ceb2c, 0xeb28eb28, 0xeb28eb28, 0xeb28, 0xe25ce258, 0xe264e260, 0xec34ebb0, 0xec34ec34, 0xea0, 0x5440, 0x8cc0, 0xd260, 0x11800, 0x15080, 0x19620
.long 0xeb28eb28, 0xeb24eb28, 0xeb24eb24, 0xeb24eb24, 0xeb24, 0xe27ce278, 0xe284e280, 0xec38ebb4, 0xec38ec38, 0xeb0, 0x5450, 0x8cd0, 0xd270, 0x11810, 0x15090, 0x19630
.long 0xeb24eb24, 0xeb24eb24, 0xeb20eb20, 0xeb20eb20, 0xeb20, 0xe29ce298, 0xe2a4e2a0, 0xec3cebb8, 0xec3cec3c, 0xec0, 0x5460, 0x9a00, 0xd280, 0x11820, 0x150a0, 0x19640
.long 0xeb20eb20, 0xeb1ceb20, 0xeb1ceb1c, 0xeb1ceb1c, 0xeb1c, 0xe2bce2b8, 0xe2c4e2c0, 0xec40ebbc, 0xec40ec40, 0xed0, 0x5470, 0x9a10, 0xd290, 0x11830, 0x150b0, 0x19650
.long 0xeb1ceb1c, 0xeb1ceb1c, 0xeb18eb18, 0xeb18eb18, 0xeb18, 0xe2e0e2dc, 0xe2e8e2e4, 0xec44ebc0, 0xec44ec44, 0x1c00, 0x5480, 0x9a20, 0xd2a0, 0x11840, 0x150c0, 0x19660
.long 0xeb18eb18, 0xeb14eb18, 0xeb14eb14, 0xeb14eb14, 0xeb14, 0xe300e2fc, 0xe308e304, 0xec48ebc4, 0xec48ec48, 0x1c10, 0x5490, 0x9a30, 0xd2b0, 0x11850, 0x150d0, 0x19670
.long 0xeb14eb14, 0xeb14eb14, 0xeb10eb10, 0xeb10eb10, 0xeb10, 0xe320e31c, 0xe328e324, 0xec4cebc8, 0xec4cec4c, 0x1c20, 0x54a0, 0x9a40, 0xd2c0, 0x11860, 0x15e00, 0x19680
.long 0xeb10eb10, 0xeb0ceb10, 0xeb0ceb0c, 0xeb0ceb0c, 0xeb0c, 0xe340e33c, 0xe348e344, 0xec50ebcc, 0xec50ec50, 0x1c30, 0x54b0, 0x9a50, 0xd2d0, 0x11870, 0x15e10, 0x19690
.long 0xeb0ceb0c, 0xeb0ceb0c, 0xeb04eb04, 0xeb04eb04, 0xeb04, 0xe564e560, 0xe56ce568, 0xec14ec14, 0xec14ec14, 0x1c40, 0x54c0, 0x9a60, 0xe000, 0x11880, 0x15e20, 0x196a0
.long 0xeb04eb04, 0xeb00eb04, 0xeb00eb00, 0xeb00eb00, 0xeb00, 0xe574e570, 0xe57ce578, 0xec18ec18, 0xec18ec18, 0x1c50, 0x54d0, 0x9a70, 0xe010, 0x11890, 0x15e30, 0x196b0
.long 0xeb00eb00, 0xeb00eb00, 0xeafceafc, 0xeafceafc, 0xeafc, 0xe584e580, 0xe58ce588, 0xec1cec1c, 0xec1cec1c, 0x1c60, 0x6200, 0x9a80, 0xe020, 0x118a0, 0x15e40, 0x196c0
.long 0xeafceafc, 0xeaf8eafc, 0xeaf8eaf8, 0xeaf8eaf8, 0xeaf8, 0xe594e590, 0xe59ce598, 0xec20ec20, 0xec20ec20, 0x1c70, 0x6210, 0x9a90, 0xe030, 0x118b0, 0x15e50, 0x196d0
.long 0xeaf8eaf8, 0xeaf8eaf8, 0xeaf4eaf4, 0xeaf4eaf4, 0xeaf4, 0xe5a4e5a0, 0xe5ace5a8, 0xec24ec24, 0xec24ec24, 0x1c80, 0x6220, 0x9aa0, 0xe040, 0x118c0, 0x15e60, 0x1a400
.long 0xeaf4eaf4, 0xeaf0eaf4, 0xeaf0eaf0, 0xeaf0eaf0, 0xeaf0, 0xe5b4e5b0, 0xe5bce5b8, 0xec28ec28, 0xec28ec28, 0x1c90, 0x6230, 0x9ab0, 0xe050, 0x118d0, 0x15e70, 0x1a410
.long 0xeaf0eaf0, 0xeaf0eaf0, 0xeaeceaec, 0xeaeceaec, 0xeaec, 0xe5c4e5c0, 0xe5cce5c8, 0xec2cec2c, 0xec2cec2c, 0x1ca0, 0x6240, 0x9ac0, 0xe060, 0x12600, 0x15e80, 0x1a420
.long 0xeaeceaec, 0xeae8eaec, 0xeae8eae8, 0xeae8eae8, 0xeae8, 0xe5d4e5d0, 0xe5dce5d8, 0xec30ec30, 0xec30ec30, 0x1cb0, 0x6250, 0x9ad0, 0xe070, 0x12610, 0x15e90, 0x1a430
.long 0xeae8eae8, 0xeae8eae8, 0xeae4eae4, 0xeae4eae4, 0xeae4, 0xe5e8e5e4, 0xe5f0e5ec, 0xec34ec34, 0xec34ec34, 0x1cc0, 0x6260, 0xa800, 0xe080, 0x12620, 0x15ea0, 0x1a440
.long 0xeae4eae4, 0xeae0eae4, 0xeae0eae0, 0xeae0eae0, 0xeae0, 0xe5f8e5f4, 0xe600e5fc, 0xec38ec38, 0xec38ec38, 0x1cd0, 0x6270, 0xa810, 0xe090, 0x12630, 0x15eb0, 0x1a450
.long 0xeae0eae0, 0xeae0eae0, 0xeadceadc, 0xeadceadc, 0xeadc, 0xe608e604, 0xe610e60c, 0xec3cec3c, 0xec3cec3c, 0x2a00, 0x6280, 0xa820, 0xe0a0, 0x12640, 0x15ec0, 0x1a460
.long 0xeadceadc, 0xead8eadc, 0xead8ead8, 0xead8ead8, 0xead8, 0xe618e614, 0xe620e61c, 0xec40ec40, 0xec40ec40, 0x2a10, 0x6290, 0xa830, 0xe0b0, 0x12650, 0x15ed0, 0x1a470
.long 0xead8ead8, 0xead8ead8, 0xead4ead4, 0xead4ead4, 0xead4, 0xe628e624, 0xe630e62c, 0xec44ec44, 0xec44ec44, 0x2a20, 0x62a0, 0xa840, 0xe0c0, 0x12660, 0x16c00, 0x1a480
.long 0xead4ead4, 0xead0ead4, 0xead0ead0, 0xead0ead0, 0xead0, 0xe638e634, 0xe640e63c, 0xec48ec48, 0xec48ec48, 0x2a30, 0x62b0, 0xa850, 0xe0d0, 0x12670, 0x16c10, 0x1a490
.long 0xead0ead0, 0xead0ead0, 0xeacceacc, 0xeacceacc, 0xeacc, 0xe648e644, 0xe650e64c, 0xec4cec4c, 0xec4cec4c, 0x2a40, 0x62c0, 0xa860, 0xee00, 0x12680, 0x16c20, 0x1a4a0
.long 0xeacceacc, 0xeac8eacc, 0xeac8eac8, 0xeac8eac8, 0xeac8, 0xe658e654, 0xe660e65c, 0xec50ec50, 0xec50ec50, 0x2a50, 0x62d0, 0xa870, 0xee10, 0x12690, 0x16c30, 0x1a4b0
.long 0xeac8eac8, 0xeac8eac8, 0xeac4eac4, 0xeac4eac4, 0xeac4, 0xe774e770, 0xe87ce878, 0xec14ec14, 0xec14ec14, 0x2a60, 0x7000, 0xa880, 0xee20, 0x126a0, 0x16c40, 0x1a4c0
.long 0xeac4eac4, 0xeac0eac4, 0xeac0eac0, 0xeac0eac0, 0xeac0, 0xe77ce778, 0xe884e880, 0xec18ec18, 0xec18ec18, 0x2a70, 0x7010, 0xa890, 0xee30, 0x126b0, 0x16c50, 0x1a4d0
.long 0xeac0eac0, 0xeac0eac0, 0xeabceabc, 0xeabceabc, 0xeabc, 0xe784e780, 0xe88ce888, 0xec1cec1c, 0xec1cec1c, 0x2a80, 0x7020, 0xa8a0, 0xee40, 0x126c0, 0x16c60, 0x1b200
.long 0xeabceabc, 0xeab8eabc, 0xeab8eab8, 0xeab8eab8, 0xeab8, 0xe78ce788, 0xe894e890, 0xec20ec20, 0xec20ec20, 0x2a90, 0x7030, 0xa8b0, 0xee50, 0x126d0, 0x16c70, 0x1b210
.long 0xeab8eab8, 0xeab8eab8, 0xeab4eab4, 0xeab4eab4, 0xeab4, 0xe794e790, 0xe89ce898, 0xec24ec24, 0xec24ec24, 0x2aa0, 0x7040, 0xa8c0, 0xee60, 0x13400, 0x16c80, 0x1b220
.long 0xeab4eab4, 0xeab0eab4, 0xeab0eab0, 0xeab0eab0, 0xeab0, 0xe79ce798, 0xe8a4e8a0, 0xec28ec28, 0xec28ec28, 0x2ab0, 0x7050, 0xa8d0, 0xee70, 0x13410, 0x16c90, 0x1b230
.long 0xeab0eab0, 0xeab0eab0, 0xeaaceaac, 0xeaaceaac, 0xeaac, 0xe7a4e7a0, 0xe8ace8a8, 0xec2cec2c, 0xec2cec2c, 0x2ac0, 0x7060, 0xb600, 0xee80, 0x13420, 0x16ca0, 0x1b240
.long 0xeaaceaac, 0xeaa8eaac, 0xeaa8eaa8, 0xeaa8eaa8, 0xeaa8, 0xe7ace7a8, 0xe8b4e8b0, 0xec30ec30, 0xec30ec30, 0x2ad0, 0x7070, 0xb610, 0xee90, 0x13430, 0x16cb0, 0x1b250
.long 0xeaa8eaa8, 0xeaa8eaa8, 0xeaa4eaa4, 0xeaa4eaa4, 0xeaa4, 0xe7b4e7b0, 0xe8bce8b8, 0xec34ec34, 0xec34ec34, 0x3800, 0x7080, 0xb620, 0xeea0, 0x13440, 0x16cc0, 0x1b260
.long 0xeaa4eaa4, 0xeaa0eaa4, 0xeaa0eaa0, 0xeaa0eaa0, 0xeaa0, 0xe7bce7b8, 0xe8c4e8c0, 0xec38ec38, 0xec38ec38, 0x3810, 0x7090, 0xb630, 0xeeb0, 0x13450, 0x16cd0, 0x1b270
.long 0xeaa0eaa0, 0xeaa0eaa0, 0xea9cea9c, 0xea9cea9c, 0xea9c, 0xe7c4e7c0, 0xe8cce8c8, 0xec3cec3c, 0xec3cec3c, 0x3820, 0x70a0, 0xb640, 0xeec0, 0x13460, 0x17a00, 0x1b280
.long 0xea9cea9c, 0xea98ea9c, 0xea98ea98, 0xea98ea98, 0xea98, 0xe7cce7c8, 0xe8d4e8d0, 0xec40ec40, 0xec40ec40, 0x3830, 0x70b0, 0xb650, 0xeed0, 0x13470, 0x17a10, 0x1b290
.long 0xea98ea98, 0xea98ea98, 0xea94ea94, 0xea94ea94, 0xea94, 0xe7d4e7d0, 0xe8dce8d8, 0xec44ec44, 0xec44ec44, 0x3840, 0x70c0, 0xb660, 0xfc00, 0x13480, 0x17a20, 0x1b2a0
.long 0xea94ea94, 0xea90ea94, 0xea90ea90, 0xea90ea90, 0xea90, 0xe7dce7d8, 0xe8e4e8e0, 0xec48ec48, 0xec48ec48, 0x3850, 0x70d0, 0xb670, 0xfc10, 0x13490, 0x17a30, 0x1b2b0
.long 0xea90ea90, 0xea90ea90, 0xea8cea8c, 0xea8cea8c, 0xea8c, 0xe7e4e7e0, 0xe8ece8e8, 0xec4cec4c, 0xec4cec4c, 0x3860, 0x7e00, 0xb680, 0xfc20, 0x134a0, 0x17a40, 0x1b2c0
.long 0xea8cea8c, 0xea88ea8c, 0xea88ea88, 0xea88ea88, 0xea88, 0xe7ece7e8, 0xe8f4e8f0, 0xec50ec50, 0xec50ec50, 0x3870, 0x7e10, 0xb690, 0xfc30, 0x134b0, 0x17a50, 0x1b2d0
.long 0xea88ea88, 0xea88ea88, 0xea80ea80, 0xea80ea80, 0xea80, 0xe354e350, 0xe35ce358, 0xea44e9c0, 0xeb4ceac8, 0x0, 0x3880, 0x7e20, 0xb6a0, 0xfc40, 0x134c0, 0x17a60
.long 0xea80ea80, 0xea7cea80, 0xea7cea7c, 0xea7cea7c, 0xea7c, 0xe374e370, 0xe37ce378, 0xea48e9c4, 0xeb50eacc, 0x10, 0x3890, 0x7e30, 0xb6b0, 0xfc50, 0x134d0, 0x17a70
.long 0xea7cea7c, 0xea7cea7c, 0xea78ea78, 0xea78ea78, 0xea78, 0xe394e390, 0xe39ce398, 0xea4ce9c8, 0xeb54ead0, 0x20, 0x38a0, 0x7e40, 0xb6c0, 0xfc60, 0x14200, 0x17a80
.long 0xea78ea78, 0xea74ea78, 0xea74ea74, 0xea74ea74, 0xea74, 0xe3b4e3b0, 0xe3bce3b8, 0xea50e9cc, 0xeb58ead4, 0x30, 0x38b0, 0x7e50, 0xb6d0, 0xfc70, 0x14210, 0x17a90
.long 0xea74ea74, 0xea74ea74, 0xea70ea70, 0xea70ea70, 0xea70, 0xe3d8e3d4, 0xe3e0e3dc, 0xea54e9d0, 0xeb5cead8, 0x40, 0x38c0, 0x7e60, 0xc400, 0xfc80, 0x14220, 0x17aa0
.long 0xea70ea70, 0xea6cea70, 0xea6cea6c, 0xea6cea6c, 0xea6c, 0xe3f8e3f4, 0xe400e3fc, 0xea58e9d4, 0xeb60eadc, 0x50, 0x38d0, 0x7e70, 0xc410, 0xfc90, 0x14230, 0x17ab0
.long 0xea6cea6c, 0xea6cea6c, 0xea68ea68, 0xea68ea68, 0xea68, 0xe418e414, 0xe420e41c, 0xea5ce9d8, 0xeb64eae0, 0x60, 0x4600, 0x7e80, 0xc420, 0xfca0, 0x14240, 0x17ac0
.long 0xea68ea68, 0xea64ea68, 0xea64ea64, 0xea64ea64, 0xea64, 0xe438e434, 0xe440e43c, 0xea60e9dc, 0xeb68eae4, 0x70, 0x4610, 0x7e90, 0xc430, 0xfcb0, 0x14250, 0x17ad0
.long 0xea64ea64, 0xea64ea64, 0xea60ea60, 0xea60ea60, 0xea60, 0xe45ce458, 0xe464e460, 0xea64e9e0, 0xeb6ceae8, 0x80, 0x4620, 0x7ea0, 0xc440, 0xfcc0, 0x14260, 0x18800
.long 0xea60ea60, 0xea5cea60, 0xea5cea5c, 0xea5cea5c, 0xea5c, 0xe47ce478, 0xe484e480, 0xea68e9e4, 0xeb70eaec, 0x90, 0x4630, 0x7eb0, 0xc450, 0xfcd0, 0x14270, 0x18810
.long 0xea5cea5c, 0xea5cea5c, 0xea58ea58, 0xea58ea58, 0xea58, 0xe49ce498, 0xe4a4e4a0, 0xea6ce9e8, 0xeb74eaf0, 0xa0, 0x4640, 0x7ec0, 0xc460, 0x10a00, 0x14280, 0x18820
.long 0xea58ea58, 0xea54ea58, 0xea54ea54, 0xea54ea54, 0xea54, 0xe4bce4b8, 0xe4c4e4c0, 0xea70e9ec, 0xeb78eaf4, 0xb0, 0x4650, 0x7ed0, 0xc470, 0x10a10, 0x14290, 0x18830
.long 0xea54ea54, 0xea54ea54, 0xea50ea50, 0xea50ea50, 0xea50, 0xe4e0e4dc, 0xe4e8e4e4, 0xea74e9f0, 0xeb7ceaf8, 0xc0, 0x4660, 0x8c00, 0xc480, 0x10a20, 0x142a0, 0x18840
.long 0xea50ea50, 0xea4cea50, 0xea4cea4c, 0xea4cea4c, 0xea4c, 0xe500e4fc, 0xe508e504, 0xea78e9f4, 0xeb80eafc, 0xd0, 0x4670, 0x8c10, 0xc490, 0x10a30, 0x142b0, 0x18850
.long 0xea4cea4c, 0xea4cea4c, 0xea48ea48, 0xea48ea48, 0xea48, 0xe520e51c, 0xe528e524, 0xea7ce9f8, 0xeb84eb00, 0xe00, 0x4680, 0x8c20, 0xc4a0, 0x10a40, 0x142c0, 0x18860
.long 0xea48ea48, 0xea44ea48, 0xea44ea44, 0xea44ea44, 0xea44, 0xe540e53c, 0xe548e544, 0xea80e9fc, 0xeb88eb04, 0xe10, 0x4690, 0x8c30, 0xc4b0, 0x10a50, 0x142d0, 0x18870
.long 0xea44ea44, 0xea44ea44, 0xea40ea40, 0xea40ea40, 0xea40, 0xe364e360, 0xe36ce368, 0xec54ebd0, 0xec54ec54, 0xe20, 0x46a0, 0x8c40, 0xc4c0, 0x10a60, 0x15000, 0x18880
.long 0xea40ea40, 0xea3cea40, 0xea3cea3c, 0xea3cea3c, 0xea3c, 0xe384e380, 0xe38ce388, 0xec58ebd4, 0xec58ec58, 0xe30, 0x46b0, 0x8c50, 0xc4d0, 0x10a70, 0x15010, 0x18890
.long 0xea3cea3c, 0xea3cea3c, 0xea38ea38, 0xea38ea38, 0xea38, 0xe3a4e3a0, 0xe3ace3a8, 0xec5cebd8, 0xec5cec5c, 0xe40, 0x46c0, 0x8c60, 0xd200, 0x10a80, 0x15020, 0x188a0
.long 0xea38ea38, 0xea34ea38, 0xea34ea34, 0xea34ea34, 0xea34, 0xe3c4e3c0, 0xe3cce3c8, 0xec60ebdc, 0xec60ec60, 0xe50, 0x46d0, 0x8c70, 0xd210, 0x10a90, 0x15030, 0x188b0
.long 0xea34ea34, 0xea34ea34, 0xea30ea30, 0xea30ea30, 0xea30, 0xe3e8e3e4, 0xe3f0e3ec, 0xec64ebe0, 0xec64ec64, 0xe60, 0x5400, 0x8c80, 0xd220, 0x10aa0, 0x15040, 0x188c0
.long 0xea30ea30, 0xea2cea30, 0xea2cea2c, 0xea2cea2c, 0xea2c, 0xe408e404, 0xe410e40c, 0xec68ebe4, 0xec68ec68, 0xe70, 0x5410, 0x8c90, 0xd230, 0x10ab0, 0x15050, 0x188d0
.long 0xea2cea2c, 0xea2cea2c, 0xea28ea28, 0xea28ea28, 0xea28, 0xe428e424, 0xe430e42c, 0xec6cebe8, 0xec6cec6c, 0xe80, 0x5420, 0x8ca0, 0xd240, 0x10ac0, 0x15060, 0x19600
.long 0xea28ea28, 0xea24ea28, 0xea24ea24, 0xea24ea24, 0xea24, 0xe448e444, 0xe450e44c, 0xec70ebec, 0xec70ec70, 0xe90, 0x5430, 0x8cb0, 0xd250, 0x10ad0, 0x15070, 0x19610
.long 0xea24ea24, 0xea24ea24, 0xea20ea20, 0xea20ea20, 0xea20, 0xe46ce468, 0xe474e470, 0xec74ebf0, 0xec74ec74, 0xea0, 0x5440, 0x8cc0, 0xd260, 0x11800, 0x15080, 0x19620
.long 0xea20ea20, 0xea1cea20, 0xea1cea1c, 0xea1cea1c, 0xea1c, 0xe48ce488, 0xe494e490, 0xec78ebf4, 0xec78ec78, 0xeb0, 0x5450, 0x8cd0, 0xd270, 0x11810, 0x15090, 0x19630
.long 0xea1cea1c, 0xea1cea1c, 0xea18ea18, 0xea18ea18, 0xea18, 0xe4ace4a8, 0xe4b4e4b0, 0xec7cebf8, 0xec7cec7c, 0xec0, 0x5460, 0x9a00, 0xd280, 0x11820, 0x150a0, 0x19640
.long 0xea18ea18, 0xea14ea18, 0xea14ea14, 0xea14ea14, 0xea14, 0xe4cce4c8, 0xe4d4e4d0, 0xec80ebfc, 0xec80ec80, 0xed0, 0x5470, 0x9a10, 0xd290, 0x11830, 0x150b0, 0x19650
.long 0xea14ea14, 0xea14ea14, 0xea10ea10, 0xea10ea10, 0xea10, 0xe4f0e4ec, 0xe4f8e4f4, 0xec84ec00, 0xec84ec84, 0x1c00, 0x5480, 0x9a20, 0xd2a0, 0x11840, 0x150c0, 0x19660
.long 0xea10ea10, 0xea0cea10, 0xea0cea0c, 0xea0cea0c, 0xea0c, 0xe510e50c, 0xe518e514, 0xec88ec04, 0xec88ec88, 0x1c10, 0x5490, 0x9a30, 0xd2b0, 0x11850, 0x150d0, 0x19670
.long 0xea0cea0c, 0xea0cea0c, 0xea08ea08, 0xea08ea08, 0xea08, 0xe530e52c, 0xe538e534, 0xec8cec08, 0xec8cec8c, 0x1c20, 0x54a0, 0x9a40, 0xd2c0, 0x11860, 0x15e00, 0x19680
.long 0xea08ea08, 0xea04ea08, 0xea04ea04, 0xea04ea04, 0xea04, 0xe550e54c, 0xe558e554, 0xec90ec0c, 0xec90ec90, 0x1c30, 0x54b0, 0x9a50, 0xd2d0, 0x11870, 0x15e10, 0x19690
.long 0xea04ea04, 0xea04ea04, 0xe9fce9fc, 0xe9fce9fc, 0xe9fc, 0xe66ce668, 0xe674e670, 0xec54ec54, 0xec54ec54, 0x1c40, 0x54c0, 0x9a60, 0xe000, 0x11880, 0x15e20, 0x196a0
.long 0xe9fce9fc, 0xe9f8e9fc, 0xe9f8e9f8, 0xe9f8e9f8, 0xe9f8, 0xe67ce678, 0xe684e680, 0xec58ec58, 0xec58ec58, 0x1c50, 0x54d0, 0x9a70, 0xe010, 0x11890, 0x15e30, 0x196b0
.long 0xe9f8e9f8, 0xe9f8e9f8, 0xe9f4e9f4, 0xe9f4e9f4, 0xe9f4, 0xe68ce688, 0xe694e690, 0xec5cec5c, 0xec5cec5c, 0x1c60, 0x6200, 0x9a80, 0xe020, 0x118a0, 0x15e40, 0x196c0
.long 0xe9f4e9f4, 0xe9f0e9f4, 0xe9f0e9f0, 0xe9f0e9f0, 0xe9f0, 0xe69ce698, 0xe6a4e6a0, 0xec60ec60, 0xec60ec60, 0x1c70, 0x6210, 0x9a90, 0xe030, 0x118b0, 0x15e50, 0x196d0
.long 0xe9f0e9f0, 0xe9f0e9f0, 0xe9ece9ec, 0xe9ece9ec, 0xe9ec, 0xe6ace6a8, 0xe6b4e6b0, 0xec64ec64, 0xec64ec64, 0x1c80, 0x6220, 0x9aa0, 0xe040, 0x118c0, 0x15e60, 0x1a400
.long 0xe9ece9ec, 0xe9e8e9ec, 0xe9e8e9e8, 0xe9e8e9e8, 0xe9e8, 0xe6bce6b8, 0xe6c4e6c0, 0xec68ec68, 0xec68ec68, 0x1c90, 0x6230, 0x9ab0, 0xe050, 0x118d0, 0x15e70, 0x1a410
.long 0xe9e8e9e8, 0xe9e8e9e8, 0xe9e4e9e4, 0xe9e4e9e4, 0xe9e4, 0xe6cce6c8, 0xe6d4e6d0, 0xec6cec6c, 0xec6cec6c, 0x1ca0, 0x6240, 0x9ac0, 0xe060, 0x12600, 0x15e80, 0x1a420
.long 0xe9e4e9e4, 0xe9e0e9e4, 0xe9e0e9e0, 0xe9e0e9e0, 0xe9e0, 0xe6dce6d8, 0xe6e4e6e0, 0xec70ec70, 0xec70ec70, 0x1cb0, 0x6250, 0x9ad0, 0xe070, 0x12610, 0x15e90, 0x1a430
.long 0xe9e0e9e0, 0xe9e0e9e0, 0xe9dce9dc, 0xe9dce9dc, 0xe9dc, 0xe6f0e6ec, 0xe6f8e6f4, 0xec74ec74, 0xec74ec74, 0x1cc0, 0x6260, 0xa800, 0xe080, 0x12620, 0x15ea0, 0x1a440
.long 0xe9dce9dc, 0xe9d8e9dc, 0xe9d8e9d8, 0xe9d8e9d8, 0xe9d8, 0xe700e6fc, 0xe708e704, 0xec78ec78, 0xec78ec78, 0x1cd0, 0x6270, 0xa810, 0xe090, 0x12630, 0x15eb0, 0x1a450
.long 0xe9d8e9d8, 0xe9d8e9d8, 0xe9d4e9d4, 0xe9d4e9d4, 0xe9d4, 0xe710e70c, 0xe718e714, 0xec7cec7c, 0xec7cec7c, 0x2a00, 0x6280, 0xa820, 0xe0a0, 0x12640, 0x15ec0, 0x1a460
.long 0xe9d4e9d4, 0xe9d0e9d4, 0xe9d0e9d0, 0xe9d0e9d0, 0xe9d0, 0xe720e71c, 0xe728e724, 0xec80ec80, 0xec80ec80, 0x2a10, 0x6290, 0xa830, 0xe0b0, 0x12650, 0x15ed0, 0x1a470
.long 0xe9d0e9d0, 0xe9d0e9d0, 0xe9cce9cc, 0xe9cce9cc, 0xe9cc, 0xe730e72c, 0xe738e734, 0xec84ec84, 0xec84ec84, 0x2a20, 0x62a0, 0xa840, 0xe0c0, 0x12660, 0x16c00, 0x1a480
.long 0xe9cce9cc, 0xe9c8e9cc, 0xe9c8e9c8, 0xe9c8e9c8, 0xe9c8, 0xe740e73c, 0xe748e744, 0xec88ec88, 0xec88ec88, 0x2a30, 0x62b0, 0xa850, 0xe0d0, 0x12670, 0x16c10, 0x1a490
.long 0xe9c8e9c8, 0xe9c8e9c8, 0xe9c4e9c4, 0xe9c4e9c4, 0xe9c4, 0xe750e74c, 0xe758e754, 0xec8cec8c, 0xec8cec8c, 0x2a40, 0x62c0, 0xa860, 0xee00, 0x12680, 0x16c20, 0x1a4a0
.long 0xe9c4e9c4, 0xe9c0e9c4, 0xe9c0e9c0, 0xe9c0e9c0, 0xe9c0, 0xe760e75c, 0xe768e764, 0xec90ec90, 0xec90ec90, 0x2a50, 0x62d0, 0xa870, 0xee10, 0x12690, 0x16c30, 0x1a4b0
.long 0xe9c0e9c0, 0xe9c0e9c0, 0xe9bce9bc, 0xe9bce9bc, 0xe9bc, 0xe7f8e7f4, 0xe900e8fc, 0xec54ec54, 0xec54ec54, 0x2a60, 0x7000, 0xa880, 0xee20, 0x126a0, 0x16c40, 0x1a4c0
.long 0xe9bce9bc, 0xe9b8e9bc, 0xe9b8e9b8, 0xe9b8e9b8, 0xe9b8, 0xe800e7fc, 0xe908e904, 0xec58ec58, 0xec58ec58, 0x2a70, 0x7010, 0xa890, 0xee30, 0x126b0, 0x16c50, 0x1a4d0
.long 0xe9b8e9b8, 0xe9b8e9b8, 0xe9b4e9b4, 0xe9b4e9b4, 0xe9b4, 0xe808e804, 0xe910e90c, 0xec5cec5c, 0xec5cec5c, 0x2a80, 0x7020, 0xa8a0, 0xee40, 0x126c0, 0x16c60, 0x1b200
.long 0xe9b4e9b4, 0xe9b0e9b4, 0xe9b0e9b0, 0xe9b0e9b0, 0xe9b0, 0xe810e80c, 0xe918e914, 0xec60ec60, 0xec60ec60, 0x2a90, 0x7030, 0xa8b0, 0xee50, 0x126d0, 0x16c70, 0x1b210
.long 0xe9b0e9b0, 0xe9b0e9b0, 0xe9ace9ac, 0xe9ace9ac, 0xe9ac, 0xe818e814, 0xe920e91c, 0xec64ec64, 0xec64ec64, 0x2aa0, 0x7040, 0xa8c0, 0xee60, 0x13400, 0x16c80, 0x1b220
.long 0xe9ace9ac, 0xe9a8e9ac, 0xe9a8e9a8, 0xe9a8e9a8, 0xe9a8, 0xe820e81c, 0xe928e924, 0xec68ec68, 0xec68ec68, 0x2ab0, 0x7050, 0xa8d0, 0xee70, 0x13410, 0x16c90, 0x1b230
.long 0xe9a8e9a8, 0xe9a8e9a8, 0xe9a4e9a4, 0xe9a4e9a4, 0xe9a4, 0xe828e824, 0xe930e92c, 0xec6cec6c, 0xec6cec6c, 0x2ac0, 0x7060, 0xb600, 0xee80, 0x13420, 0x16ca0, 0x1b240
.long 0xe9a4e9a4, 0xe9a0e9a4, 0xe9a0e9a0, 0xe9a0e9a0, 0xe9a0, 0xe830e82c, 0xe938e934, 0xec70ec70, 0xec70ec70, 0x2ad0, 0x7070, 0xb610, 0xee90, 0x13430, 0x16cb0, 0x1b250
.long 0xe9a0e9a0, 0xe9a0e9a0, 0xe99ce99c, 0xe99ce99c, 0xe99c, 0xe838e834, 0xe940e93c, 0xec74ec74, 0xec74ec74, 0x3800, 0x7080, 0xb620, 0xeea0, 0x13440, 0x16cc0, 0x1b260
.long 0xe99ce99c, 0xe998e99c, 0xe998e998, 0xe998e998, 0xe998, 0xe840e83c, 0xe948e944, 0xec78ec78, 0xec78ec78, 0x3810, 0x7090, 0xb630, 0xeeb0, 0x13450, 0x16cd0, 0x1b270
.long 0xe998e998, 0xe998e998, 0xe994e994, 0xe994e994, 0xe994, 0xe848e844, 0xe950e94c, 0xec7cec7c, 0xec7cec7c, 0x3820, 0x70a0, 0xb640, 0xeec0, 0x13460, 0x17a00, 0x1b280
.long 0xe994e994, 0xe990e994, 0xe990e990, 0xe990e990, 0xe990, 0xe850e84c, 0xe958e954, 0xec80ec80, 0xec80ec80, 0x3830, 0x70b0, 0xb650, 0xeed0, 0x13470, 0x17a10, 0x1b290
.long 0xe990e990, 0xe990e990, 0xe98ce98c, 0xe98ce98c, 0xe98c, 0xe858e854, 0xe960e95c, 0xec84ec84, 0xec84ec84, 0x3840, 0x70c0, 0xb660, 0xfc00, 0x13480, 0x17a20, 0x1b2a0
.long 0xe98ce98c, 0xe988e98c, 0xe988e988, 0xe988e988, 0xe988, 0xe860e85c, 0xe968e964, 0xec88ec88, 0xec88ec88, 0x3850, 0x70d0, 0xb670, 0xfc10, 0x13490, 0x17a30, 0x1b2b0
.long 0xe988e988, 0xe988e988, 0xe984e984, 0xe984e984, 0xe984, 0xe868e864, 0xe970e96c, 0xec8cec8c, 0xec8cec8c, 0x3860, 0x7e00, 0xb680, 0xfc20, 0x134a0, 0x17a40, 0x1b2c0
.long 0xe984e984, 0xe980e984, 0xe980e980, 0xe980e980, 0xe980, 0xe870e86c, 0xe978e974, 0xec90ec90, 0xec90ec90, 0x3870, 0x7e10, 0xb690, 0xfc30, 0x134b0, 0x17a50, 0x1b2d0
.long 0xe980e980, 0xe978e978, 0xe974e978, 0xe974e974, 0xe974, 0xecc4ecc0, 0xecccecc8, 0xf584f500, 0xf68cf608, 0x0, 0x3880, 0x7e20, 0xb6a0, 0xfc40, 0x134c0, 0x17a60
.long 0xe974e974, 0xe970e970, 0xe96ce970, 0xe96ce96c, 0xe96c, 0xece4ece0, 0xececece8, 0xf588f504, 0xf690f60c, 0x10, 0x3890, 0x7e30, 0xb6b0, 0xfc50, 0x134d0, 0x17a70
.long 0xe96ce96c, 0xe968e968, 0xe964e968, 0xe964e964, 0xe964, 0xed04ed00, 0xed0ced08, 0xf58cf508, 0xf694f610, 0x20, 0x38a0, 0x7e40, 0xb6c0, 0xfc60, 0x14200, 0x17a80
.long 0xe964e964, 0xe960e960, 0xe95ce960, 0xe95ce95c, 0xe95c, 0xed24ed20, 0xed2ced28, 0xf590f50c, 0xf698f614, 0x30, 0x38b0, 0x7e50, 0xb6d0, 0xfc70, 0x14210, 0x17a90
.long 0xe95ce95c, 0xe958e958, 0xe954e958, 0xe954e954, 0xe954, 0xed48ed44, 0xed50ed4c, 0xf594f510, 0xf69cf618, 0x40, 0x38c0, 0x7e60, 0xc400, 0xfc80, 0x14220, 0x17aa0
.long 0xe954e954, 0xe950e950, 0xe94ce950, 0xe94ce94c, 0xe94c, 0xed68ed64, 0xed70ed6c, 0xf598f514, 0xf6a0f61c, 0x50, 0x38d0, 0x7e70, 0xc410, 0xfc90, 0x14230, 0x17ab0
.long 0xe94ce94c, 0xe948e948, 0xe944e948, 0xe944e944, 0xe944, 0xed88ed84, 0xed90ed8c, 0xf59cf518, 0xf6a4f620, 0x60, 0x4600, 0x7e80, 0xc420, 0xfca0, 0x14240, 0x17ac0
.long 0xe944e944, 0xe940e940, 0xe93ce940, 0xe93ce93c, 0xe93c, 0xeda8eda4, 0xedb0edac, 0xf5a0f51c, 0xf6a8f624, 0x70, 0x4610, 0x7e90, 0xc430, 0xfcb0, 0x14250, 0x17ad0
.long 0xe93ce93c, 0xe938e938, 0xe934e938, 0xe934e934, 0xe934, 0xedccedc8, 0xedd4edd0, 0xf5a4f520, 0xf6acf628, 0x80, 0x4620, 0x7ea0, 0xc440, 0xfcc0, 0x14260, 0x18800
.long 0xe934e934, 0xe930e930, 0xe92ce930, 0xe92ce92c, 0xe92c, 0xedecede8, 0xedf4edf0, 0xf5a8f524, 0xf6b0f62c, 0x90, 0x4630, 0x7eb0, 0xc450, 0xfcd0, 0x14270, 0x18810
.long 0xe92ce92c, 0xe928e928, 0xe924e928, 0xe924e924, 0xe924, 0xee0cee08, 0xee14ee10, 0xf5acf528, 0xf6b4f630, 0xa0, 0x4640, 0x7ec0, 0xc460, 0x10a00, 0x14280, 0x18820
.long 0xe924e924, 0xe920e920, 0xe91ce920, 0xe91ce91c, 0xe91c, 0xee2cee28, 0xee34ee30, 0xf5b0f52c, 0xf6b8f634, 0xb0, 0x4650, 0x7ed0, 0xc470, 0x10a10, 0x14290, 0x18830
.long 0xe91ce91c, 0xe918e918, 0xe914e918, 0xe914e914, 0xe914, 0xee50ee4c, 0xee58ee54, 0xf5b4f530, 0xf6bcf638, 0xc0, 0x4660, 0x8c00, 0xc480, 0x10a20, 0x142a0, 0x18840
.long 0xe914e914, 0xe910e910, 0xe90ce910, 0xe90ce90c, 0xe90c, 0xee70ee6c, 0xee78ee74, 0xf5b8f534, 0xf6c0f63c, 0xd0, 0x4670, 0x8c10, 0xc490, 0x10a30, 0x142b0, 0x18850
.long 0xe90ce90c, 0xe908e908, 0xe904e908, 0xe904e904, 0xe904, 0xee90ee8c, 0xee98ee94, 0xf5bcf538, 0xf6c4f640, 0xe00, 0x4680, 0x8c20, 0xc4a0, 0x10a40, 0x142c0, 0x18860
.long 0xe904e904, 0xe900e900, 0xe8fce900, 0xe8fce8fc, 0xe8fc, 0xeeb0eeac, 0xeeb8eeb4, 0xf5c0f53c, 0xf6c8f644, 0xe10, 0x4690, 0x8c30, 0xc4b0, 0x10a50, 0x142d0, 0x18870
.long 0xe8fce8fc, 0xe8f4e8f4, 0xe8f0e8f4, 0xe8f0e8f0, 0xe8f0, 0xecd4ecd0, 0xecdcecd8, 0xf794f710, 0xf794f794, 0xe20, 0x46a0, 0x8c40, 0xc4c0, 0x10a60, 0x15000, 0x18880
.long 0xe8f0e8f0, 0xe8ece8ec, 0xe8e8e8ec, 0xe8e8e8e8, 0xe8e8, 0xecf4ecf0, 0xecfcecf8, 0xf798f714, 0xf798f798, 0xe30, 0x46b0, 0x8c50, 0xc4d0, 0x10a70, 0x15010, 0x18890
.long 0xe8e8e8e8, 0xe8e4e8e4, 0xe8e0e8e4, 0xe8e0e8e0, 0xe8e0, 0xed14ed10, 0xed1ced18, 0xf79cf718, 0xf79cf79c, 0xe40, 0x46c0, 0x8c60, 0xd200, 0x10a80, 0x15020, 0x188a0
.long 0xe8e0e8e0, 0xe8dce8dc, 0xe8d8e8dc, 0xe8d8e8d8, 0xe8d8, 0xed34ed30, 0xed3ced38, 0xf7a0f71c, 0xf7a0f7a0, 0xe50, 0x46d0, 0x8c70, 0xd210, 0x10a90, 0x15030, 0x188b0
.long 0xe8d8e8d8, 0xe8d4e8d4, 0xe8d0e8d4, 0xe8d0e8d0, 0xe8d0, 0xed58ed54, 0xed60ed5c, 0xf7a4f720, 0xf7a4f7a4, 0xe60, 0x5400, 0x8c80, 0xd220, 0x10aa0, 0x15040, 0x188c0
.long 0xe8d0e8d0, 0xe8cce8cc, 0xe8c8e8cc, 0xe8c8e8c8, 0xe8c8, 0xed78ed74, 0xed80ed7c, 0xf7a8f724, 0xf7a8f7a8, 0xe70, 0x5410, 0x8c90, 0xd230, 0x10ab0, 0x15050, 0x188d0
.long 0xe8c8e8c8, 0xe8c4e8c4, 0xe8c0e8c4, 0xe8c0e8c0, 0xe8c0, 0xed98ed94, 0xeda0ed9c, 0xf7acf728, 0xf7acf7ac, 0xe80, 0x5420, 0x8ca0, 0xd240, 0x10ac0, 0x15060, 0x19600
.long 0xe8c0e8c0, 0xe8bce8bc, 0xe8b8e8bc, 0xe8b8e8b8, 0xe8b8, 0xedb8edb4, 0xedc0edbc, 0xf7b0f72c, 0xf7b0f7b0, 0xe90, 0x5430, 0x8cb0, 0xd250, 0x10ad0, 0x15070, 0x19610
.long 0xe8b8e8b8, 0xe8b4e8b4, 0xe8b0e8b4, 0xe8b0e8b0, 0xe8b0, 0xeddcedd8, 0xede4ede0, 0xf7b4f730, 0xf7b4f7b4, 0xea0, 0x5440, 0x8cc0, 0xd260, 0x11800, 0x15080, 0x19620
.long 0xe8b0e8b0, 0xe8ace8ac, 0xe8a8e8ac, 0xe8a8e8a8, 0xe8a8, 0xedfcedf8, 0xee04ee00, 0xf7b8f734, 0xf7b8f7b8, 0xeb0, 0x5450, 0x8cd0, 0xd270, 0x11810, 0x15090, 0x19630
.long 0xe8a8e8a8, 0xe8a4e8a4, 0xe8a0e8a4, 0xe8a0e8a0, 0xe8a0, 0xee1cee18, 0xee24ee20, 0xf7bcf738, 0xf7bcf7bc, 0xec0, 0x5460, 0x9a00, 0xd280, 0x11820, 0x150a0, 0x19640
.long 0xe8a0e8a0, 0xe89ce89c, 0xe898e89c, 0xe898e898, 0xe898, 0xee3cee38, 0xee44ee40, 0xf7c0f73c, 0xf7c0f7c0, 0xed0, 0x5470, 0x9a10, 0xd290, 0x11830, 0x150b0, 0x19650
.long 0xe898e898, 0xe894e894, 0xe890e894, 0xe890e890, 0xe890, 0xee60ee5c, 0xee68ee64, 0xf7c4f740, 0xf7c4f7c4, 0x1c00, 0x5480, 0x9a20, 0xd2a0, 0x11840, 0x150c0, 0x19660
.long 0xe890e890, 0xe88ce88c, 0xe888e88c, 0xe888e888, 0xe888, 0xee80ee7c, 0xee88ee84, 0xf7c8f744, 0xf7c8f7c8, 0x1c10, 0x5490, 0x9a30, 0xd2b0, 0x11850, 0x150d0, 0x19670
.long 0xe888e888, 0xe884e884, 0xe880e884, 0xe880e880, 0xe880, 0xeea0ee9c, 0xeea8eea4, 0xf7ccf748, 0xf7ccf7cc, 0x1c20, 0x54a0, 0x9a40, 0xd2c0, 0x11860, 0x15e00, 0x19680
.long 0xe880e880, 0xe87ce87c, 0xe878e87c, 0xe878e878, 0xe878, 0xeec0eebc, 0xeec8eec4, 0xf7d0f74c, 0xf7d0f7d0, 0x1c30, 0x54b0, 0x9a50, 0xd2d0, 0x11870, 0x15e10, 0x19690
.long 0xe878e878, 0xe870e870, 0xe86ce870, 0xe86ce86c, 0xe86c, 0xf0e4f0e0, 0xf0ecf0e8, 0xf794f794, 0xf794f794, 0x1c40, 0x54c0, 0x9a60, 0xe000, 0x11880, 0x15e20, 0x196a0
.long 0xe86ce86c, 0xe868e868, 0xe864e868, 0xe864e864, 0xe864, 0xf0f4f0f0, 0xf0fcf0f8, 0xf798f798, 0xf798f798, 0x1c50, 0x54d0, 0x9a70, 0xe010, 0x11890, 0x15e30, 0x196b0
.long 0xe864e864, 0xe860e860, 0xe85ce860, 0xe85ce85c, 0xe85c, 0xf104f100, 0xf10cf108, 0xf79cf79c, 0xf79cf79c, 0x1c60, 0x6200, 0x9a80, 0xe020, 0x118a0, 0x15e40, 0x196c0
.long 0xe85ce85c, 0xe858e858, 0xe854e858, 0xe854e854, 0xe854, 0xf114f110, 0xf11cf118, 0xf7a0f7a0, 0xf7a0f7a0, 0x1c70, 0x6210, 0x9a90, 0xe030, 0x118b0, 0x15e50, 0x196d0
.long 0xe854e854, 0xe850e850, 0xe84ce850, 0xe84ce84c, 0xe84c, 0xf124f120, 0xf12cf128, 0xf7a4f7a4, 0xf7a4f7a4, 0x1c80, 0x6220, 0x9aa0, 0xe040, 0x118c0, 0x15e60, 0x1a400
.long 0xe84ce84c, 0xe848e848, 0xe844e848, 0xe844e844, 0xe844, 0xf134f130, 0xf13cf138, 0xf7a8f7a8, 0xf7a8f7a8, 0x1c90, 0x6230, 0x9ab0, 0xe050, 0x118d0, 0x15e70, 0x1a410
.long 0xe844e844, 0xe840e840, 0xe83ce840, 0xe83ce83c, 0xe83c, 0xf144f140, 0xf14cf148, 0xf7acf7ac, 0xf7acf7ac, 0x1ca0, 0x6240, 0x9ac0, 0xe060, 0x12600, 0x15e80, 0x1a420
.long 0xe83ce83c, 0xe838e838, 0xe834e838, 0xe834e834, 0xe834, 0xf154f150, 0xf15cf158, 0xf7b0f7b0, 0xf7b0f7b0, 0x1cb0, 0x6250, 0x9ad0, 0xe070, 0x12610, 0x15e90, 0x1a430
.long 0xe834e834, 0xe830e830, 0xe82ce830, 0xe82ce82c, 0xe82c, 0xf168f164, 0xf170f16c, 0xf7b4f7b4, 0xf7b4f7b4, 0x1cc0, 0x6260, 0xa800, 0xe080, 0x12620, 0x15ea0, 0x1a440
.long 0xe82ce82c, 0xe828e828, 0xe824e828, 0xe824e824, 0xe824, 0xf178f174, 0xf180f17c, 0xf7b8f7b8, 0xf7b8f7b8, 0x1cd0, 0x6270, 0xa810, 0xe090, 0x12630, 0x15eb0, 0x1a450
.long 0xe824e824, 0xe820e820, 0xe81ce820, 0xe81ce81c, 0xe81c, 0xf188f184, 0xf190f18c, 0xf7bcf7bc, 0xf7bcf7bc, 0x2a00, 0x6280, 0xa820, 0xe0a0, 0x12640, 0x15ec0, 0x1a460
.long 0xe81ce81c, 0xe818e818, 0xe814e818, 0xe814e814, 0xe814, 0xf198f194, 0xf1a0f19c, 0xf7c0f7c0, 0xf7c0f7c0, 0x2a10, 0x6290, 0xa830, 0xe0b0, 0x12650, 0x15ed0, 0x1a470
.long 0xe814e814, 0xe810e810, 0xe80ce810, 0xe80ce80c, 0xe80c, 0xf1a8f1a4, 0xf1b0f1ac, 0xf7c4f7c4, 0xf7c4f7c4, 0x2a20, 0x62a0, 0xa840, 0xe0c0, 0x12660, 0x16c00, 0x1a480
.long 0xe80ce80c, 0xe808e808, 0xe804e808, 0xe804e804, 0xe804, 0xf1b8f1b4, 0xf1c0f1bc, 0xf7c8f7c8, 0xf7c8f7c8, 0x2a30, 0x62b0, 0xa850, 0xe0d0, 0x12670, 0x16c10, 0x1a490
.long 0xe804e804, 0xe800e800, 0xe7fce800, 0xe7fce7fc, 0xe7fc, 0xf1c8f1c4, 0xf1d0f1cc, 0xf7ccf7cc, 0xf7ccf7cc, 0x2a40, 0x62c0, 0xa860, 0xee00, 0x12680, 0x16c20, 0x1a4a0
.long 0xe7fce7fc, 0xe7f8e7f8, 0xe7f4e7f8, 0xe7f4e7f4, 0xe7f4, 0xf1d8f1d4, 0xf1e0f1dc, 0xf7d0f7d0, 0xf7d0f7d0, 0x2a50, 0x62d0, 0xa870, 0xee10, 0x12690, 0x16c30, 0x1a4b0
.long 0xe7f4e7f4, 0xe7ece7ec, 0xe7e8e7ec, 0xe7e8e7e8, 0xe7e8, 0xf2f4f2f0, 0xf3fcf3f8, 0xf794f794, 0xf794f794, 0x2a60, 0x7000, 0xa880, 0xee20, 0x126a0, 0x16c40, 0x1a4c0
.long 0xe7e8e7e8, 0xe7e4e7e4, 0xe7e0e7e4, 0xe7e0e7e0, 0xe7e0, 0xf2fcf2f8, 0xf404f400, 0xf798f798, 0xf798f798, 0x2a70, 0x7010, 0xa890, 0xee30, 0x126b0, 0x16c50, 0x1a4d0
.long 0xe7e0e7e0, 0xe7dce7dc, 0xe7d8e7dc, 0xe7d8e7d8, 0xe7d8, 0xf304f300, 0xf40cf408, 0xf79cf79c, 0xf79cf79c, 0x2a80, 0x7020, 0xa8a0, 0xee40, 0x126c0, 0x16c60, 0x1b200
.long 0xe7d8e7d8, 0xe7d4e7d4, 0xe7d0e7d4, 0xe7d0e7d0, 0xe7d0, 0xf30cf308, 0xf414f410, 0xf7a0f7a0, 0xf7a0f7a0, 0x2a90, 0x7030, 0xa8b0, 0xee50, 0x126d0, 0x16c70, 0x1b210
.long 0xe7d0e7d0, 0xe7cce7cc, 0xe7c8e7cc, 0xe7c8e7c8, 0xe7c8, 0xf314f310, 0xf41cf418, 0xf7a4f7a4, 0xf7a4f7a4, 0x2aa0, 0x7040, 0xa8c0, 0xee60, 0x13400, 0x16c80, 0x1b220
.long 0xe7c8e7c8, 0xe7c4e7c4, 0xe7c0e7c4, 0xe7c0e7c0, 0xe7c0, 0xf31cf318, 0xf424f420, 0xf7a8f7a8, 0xf7a8f7a8, 0x2ab0, 0x7050, 0xa8d0, 0xee70, 0x13410, 0x16c90, 0x1b230
.long 0xe7c0e7c0, 0xe7bce7bc, 0xe7b8e7bc, 0xe7b8e7b8, 0xe7b8, 0xf324f320, 0xf42cf428, 0xf7acf7ac, 0xf7acf7ac, 0x2ac0, 0x7060, 0xb600, 0xee80, 0x13420, 0x16ca0, 0x1b240
.long 0xe7b8e7b8, 0xe7b4e7b4, 0xe7b0e7b4, 0xe7b0e7b0, 0xe7b0, 0xf32cf328, 0xf434f430, 0xf7b0f7b0, 0xf7b0f7b0, 0x2ad0, 0x7070, 0xb610, 0xee90, 0x13430, 0x16cb0, 0x1b250
.long 0xe7b0e7b0, 0xe7ace7ac, 0xe7a8e7ac, 0xe7a8e7a8, 0xe7a8, 0xf334f330, 0xf43cf438, 0xf7b4f7b4, 0xf7b4f7b4, 0x3800, 0x7080, 0xb620, 0xeea0, 0x13440, 0x16cc0, 0x1b260
.long 0xe7a8e7a8, 0xe7a4e7a4, 0xe7a0e7a4, 0xe7a0e7a0, 0xe7a0, 0xf33cf338, 0xf444f440, 0xf7b8f7b8, 0xf7b8f7b8, 0x3810, 0x7090, 0xb630, 0xeeb0, 0x13450, 0x16cd0, 0x1b270
.long 0xe7a0e7a0, 0xe79ce79c, 0xe798e79c, 0xe798e798, 0xe798, 0xf344f340, 0xf44cf448, 0xf7bcf7bc, 0xf7bcf7bc, 0x3820, 0x70a0, 0xb640, 0xeec0, 0x13460, 0x17a00, 0x1b280
.long 0xe798e798, 0xe794e794, 0xe790e794, 0xe790e790, 0xe790, 0xf34cf348, 0xf454f450, 0xf7c0f7c0, 0xf7c0f7c0, 0x3830, 0x70b0, 0xb650, 0xeed0, 0x13470, 0x17a10, 0x1b290
.long 0xe790e790, 0xe78ce78c, 0xe788e78c, 0xe788e788, 0xe788, 0xf354f350, 0xf45cf458, 0xf7c4f7c4, 0xf7c4f7c4, 0x3840, 0x70c0, 0xb660, 0xfc00, 0x13480, 0x17a20, 0x1b2a0
.long 0xe788e788, 0xe784e784, 0xe780e784, 0xe780e780, 0xe780, 0xf35cf358, 0xf464f460, 0xf7c8f7c8, 0xf7c8f7c8, 0x3850, 0x70d0, 0xb670, 0xfc10, 0x13490, 0x17a30, 0x1b2b0
.long 0xe780e780, 0xe77ce77c, 0xe778e77c, 0xe778e778, 0xe778, 0xf364f360, 0xf46cf468, 0xf7ccf7cc, 0xf7ccf7cc, 0x3860, 0x7e00, 0xb680, 0xfc20, 0x134a0, 0x17a40, 0x1b2c0
.long 0xe778e778, 0xe774e774, 0xe770e774, 0xe770e770, 0xe770, 0xf36cf368, 0xf474f470, 0xf7d0f7d0, 0xf7d0f7d0, 0x3870, 0x7e10, 0xb690, 0xfc30, 0x134b0, 0x17a50, 0x1b2d0
.long 0xe768e770, 0xe764e764, 0xe760e764, 0xe75ce75c, 0xe75c, 0xeed4eed0, 0xeedceed8, 0xf5c4f540, 0xf6ccf648, 0x0, 0x3880, 0x7e20, 0xb6a0, 0xfc40, 0x134c0, 0x17a60
.long 0xe758e75c, 0xe754e754, 0xe750e754, 0xe74ce74c, 0xe74c, 0xeef4eef0, 0xeefceef8, 0xf5c8f544, 0xf6d0f64c, 0x10, 0x3890, 0x7e30, 0xb6b0, 0xfc50, 0x134d0, 0x17a70
.long 0xe748e74c, 0xe744e744, 0xe740e744, 0xe73ce73c, 0xe73c, 0xef14ef10, 0xef1cef18, 0xf5ccf548, 0xf6d4f650, 0x20, 0x38a0, 0x7e40, 0xb6c0, 0xfc60, 0x14200, 0x17a80
.long 0xe738e73c, 0xe734e734, 0xe730e734, 0xe72ce72c, 0xe72c, 0xef34ef30, 0xef3cef38, 0xf5d0f54c, 0xf6d8f654, 0x30, 0x38b0, 0x7e50, 0xb6d0, 0xfc70, 0x14210, 0x17a90
.long 0xe728e72c, 0xe724e724, 0xe720e724, 0xe71ce71c, 0xe71c, 0xef58ef54, 0xef60ef5c, 0xf5d4f550, 0xf6dcf658, 0x40, 0x38c0, 0x7e60, 0xc400, 0xfc80, 0x14220, 0x17aa0
.long 0xe718e71c, 0xe714e714, 0xe710e714, 0xe70ce70c, 0xe70c, 0xef78ef74, 0xef80ef7c, 0xf5d8f554, 0xf6e0f65c, 0x50, 0x38d0, 0x7e70, 0xc410, 0xfc90, 0x14230, 0x17ab0
.long 0xe708e70c, 0xe704e704, 0xe700e704, 0xe6fce6fc, 0xe6fc, 0xef98ef94, 0xefa0ef9c, 0xf5dcf558, 0xf6e4f660, 0x60, 0x4600, 0x7e80, 0xc420, 0xfca0, 0x14240, 0x17ac0
.long 0xe6f8e6fc, 0xe6f4e6f4, 0xe6f0e6f4, 0xe6ece6ec, 0xe6ec, 0xefb8efb4, 0xefc0efbc, 0xf5e0f55c, 0xf6e8f664, 0x70, 0x4610, 0x7e90, 0xc430, 0xfcb0, 0x14250, 0x17ad0
.long 0xe6e4e6ec, 0xe6e0e6e0, 0xe6dce6e0, 0xe6d8e6d8, 0xe6d8, 0xefdcefd8, 0xefe4efe0, 0xf5e4f560, 0xf6ecf668, 0x80, 0x4620, 0x7ea0, 0xc440, 0xfcc0, 0x14260, 0x18800
.long 0xe6d4e6d8, 0xe6d0e6d0, 0xe6cce6d0, 0xe6c8e6c8, 0xe6c8, 0xeffceff8, 0xf004f000, 0xf5e8f564, 0xf6f0f66c, 0x90, 0x4630, 0x7eb0, 0xc450, 0xfcd0, 0x14270, 0x18810
.long 0xe6c4e6c8, 0xe6c0e6c0, 0xe6bce6c0, 0xe6b8e6b8, 0xe6b8, 0xf01cf018, 0xf024f020, 0xf5ecf568, 0xf6f4f670, 0xa0, 0x4640, 0x7ec0, 0xc460, 0x10a00, 0x14280, 0x18820
.long 0xe6b4e6b8, 0xe6b0e6b0, 0xe6ace6b0, 0xe6a8e6a8, 0xe6a8, 0xf03cf038, 0xf044f040, 0xf5f0f56c, 0xf6f8f674, 0xb0, 0x4650, 0x7ed0, 0xc470, 0x10a10, 0x14290, 0x18830
.long 0xe6a4e6a8, 0xe6a0e6a0, 0xe69ce6a0, 0xe698e698, 0xe698, 0xf060f05c, 0xf068f064, 0xf5f4f570, 0xf6fcf678, 0xc0, 0x4660, 0x8c00, 0xc480, 0x10a20, 0x142a0, 0x18840
.long 0xe694e698, 0xe690e690, 0xe68ce690, 0xe688e688, 0xe688, 0xf080f07c, 0xf088f084, 0xf5f8f574, 0xf700f67c, 0xd0, 0x4670, 0x8c10, 0xc490, 0x10a30, 0x142b0, 0x18850
.long 0xe684e688, 0xe680e680, 0xe67ce680, 0xe678e678, 0xe678, 0xf0a0f09c, 0xf0a8f0a4, 0xf5fcf578, 0xf704f680, 0xe00, 0x4680, 0x8c20, 0xc4a0, 0x10a40, 0x142c0, 0x18860
.long 0xe674e678, 0xe670e670, 0xe66ce670, 0xe668e668, 0xe668, 0xf0c0f0bc, 0xf0c8f0c4, 0xf600f57c, 0xf708f684, 0xe10, 0x4690, 0x8c30, 0xc4b0, 0x10a50, 0x142d0, 0x18870
.long 0xe660e668, 0xe65ce65c, 0xe658e65c, 0xe654e654, 0xe654, 0xeee4eee0, 0xeeeceee8, 0xf7d4f750, 0xf7d4f7d4, 0xe20, 0x46a0, 0x8c40, 0xc4c0, 0x10a60, 0x15000, 0x18880
.long 0xe650e654, 0xe64ce64c, 0xe648e64c, 0xe644e644, 0xe644, 0xef04ef00, 0xef0cef08, 0xf7d8f754, 0xf7d8f7d8, 0xe30, 0x46b0, 0x8c50, 0xc4d0, 0x10a70, 0x15010, 0x18890
.long 0xe640e644, 0xe63ce63c, 0xe638e63c, 0xe634e634, 0xe634, 0xef24ef20, 0xef2cef28, 0xf7dcf758, 0xf7dcf7dc, 0xe40, 0x46c0, 0x8c60, 0xd200, 0x10a80, 0x15020, 0x188a0
.long 0xe630e634, 0xe62ce62c, 0xe628e62c, 0xe624e624, 0xe624, 0xef44ef40, 0xef4cef48, 0xf7e0f75c, 0xf7e0f7e0, 0xe50, 0x46d0, 0x8c70, 0xd210, 0x10a90, 0x15030, 0x188b0
.long 0xe620e624, 0xe61ce61c, 0xe618e61c, 0xe614e614, 0xe614, 0xef68ef64, 0xef70ef6c, 0xf7e4f760, 0xf7e4f7e4, 0xe60, 0x5400, 0x8c80, 0xd220, 0x10aa0, 0x15040, 0x188c0
.long 0xe610e614, 0xe60ce60c, 0xe608e60c, 0xe604e604, 0xe604, 0xef88ef84, 0xef90ef8c, 0xf7e8f764, 0xf7e8f7e8, 0xe70, 0x5410, 0x8c90, 0xd230, 0x10ab0, 0x15050, 0x188d0
.long 0xe600e604, 0xe5fce5fc, 0xe5f8e5fc, 0xe5f4e5f4, 0xe5f4, 0xefa8efa4, 0xefb0efac, 0xf7ecf768, 0xf7ecf7ec, 0xe80, 0x5420, 0x8ca0, 0xd240, 0x10ac0, 0x15060, 0x19600
.long 0xe5f0e5f4, 0xe5ece5ec, 0xe5e8e5ec, 0xe5e4e5e4, 0xe5e4, 0xefc8efc4, 0xefd0efcc, 0xf7f0f76c, 0xf7f0f7f0, 0xe90, 0x5430, 0x8cb0, 0xd250, 0x10ad0, 0x15070, 0x19610
.long 0xe5dce5e4, 0xe5d8e5d8, 0xe5d4e5d8, 0xe5d0e5d0, 0xe5d0, 0xefecefe8, 0xeff4eff0, 0xf7f4f770, 0xf7f4f7f4, 0xea0, 0x5440, 0x8cc0, 0xd260, 0x11800, 0x15080, 0x19620
.long 0xe5cce5d0, 0xe5c8e5c8, 0xe5c4e5c8, 0xe5c0e5c0, 0xe5c0, 0xf00cf008, 0xf014f010, 0xf7f8f774, 0xf7f8f7f8, 0xeb0, 0x5450, 0x8cd0, 0xd270, 0x11810, 0x15090, 0x19630
.long 0xe5bce5c0, 0xe5b8e5b8, 0xe5b4e5b8, 0xe5b0e5b0, 0xe5b0, 0xf02cf028, 0xf034f030, 0xf7fcf778, 0xf7fcf7fc, 0xec0, 0x5460, 0x9a00, 0xd280, 0x11820, 0x150a0, 0x19640
.long 0xe5ace5b0, 0xe5a8e5a8, 0xe5a4e5a8, 0xe5a0e5a0, 0xe5a0, 0xf04cf048, 0xf054f050, 0xf800f77c, 0xf800f800, 0xed0, 0x5470, 0x9a10, 0xd290, 0x11830, 0x150b0, 0x19650
.long 0xe59ce5a0, 0xe598e598, 0xe594e598, 0xe590e590, 0xe590, 0xf070f06c, 0xf078f074, 0xf804f780, 0xf804f804, 0x1c00, 0x5480, 0x9a20, 0xd2a0, 0x11840, 0x150c0, 0x19660
.long 0xe58ce590, 0xe588e588, 0xe584e588, 0xe580e580, 0xe580, 0xf090f08c, 0xf098f094, 0xf808f784, 0xf808f808, 0x1c10, 0x5490, 0x9a30, 0xd2b0, 0x11850, 0x150d0, 0x19670
.long 0xe57ce580, 0xe578e578, 0xe574e578, 0xe570e570, 0xe570, 0xf0b0f0ac, 0xf0b8f0b4, 0xf80cf788, 0xf80cf80c, 0x1c20, 0x54a0, 0x9a40, 0xd2c0, 0x11860, 0x15e00, 0x19680
.long 0xe56ce570, 0xe568e568, 0xe564e568, 0xe560e560, 0xe558, 0xf0d0f0cc, 0xf0d8f0d4, 0xf810f78c, 0xf810f810, 0x1c30, 0x54b0, 0x9a50, 0xd2d0, 0x11870, 0x15e10, 0x19690
.long 0xe554e558, 0xe54ce550, 0xe544e548, 0xe53ce540, 0xe538, 0xf1ecf1e8, 0xf1f4f1f0, 0xf7d4f7d4, 0xf7d4f7d4, 0x1c40, 0x54c0, 0x9a60, 0xe000, 0x11880, 0x15e20, 0x196a0
.long 0xe534e538, 0xe52ce530, 0xe524e528, 0xe51ce520, 0xe518, 0xf1fcf1f8, 0xf204f200, 0xf7d8f7d8, 0xf7d8f7d8, 0x1c50, 0x54d0, 0x9a70, 0xe010, 0x11890, 0x15e30, 0x196b0
.long 0xe514e518, 0xe50ce510, 0xe504e508, 0xe4fce500, 0xe4f8, 0xf20cf208, 0xf214f210, 0xf7dcf7dc, 0xf7dcf7dc, 0x1c60, 0x6200, 0x9a80, 0xe020, 0x118a0, 0x15e40, 0x196c0
.long 0xe4f4e4f8, 0xe4ece4f0, 0xe4e4e4e8, 0xe4dce4e0, 0xe4d4, 0xf21cf218, 0xf224f220, 0xf7e0f7e0, 0xf7e0f7e0, 0x1c70, 0x6210, 0x9a90, 0xe030, 0x118b0, 0x15e50, 0x196d0
.long 0xe4d0e4d4, 0xe4c8e4cc, 0xe4c0e4c4, 0xe4b8e4bc, 0xe4b4, 0xf22cf228, 0xf234f230, 0xf7e4f7e4, 0xf7e4f7e4, 0x1c80, 0x6220, 0x9aa0, 0xe040, 0x118c0, 0x15e60, 0x1a400
.long 0xe4b0e4b4, 0xe4a8e4ac, 0xe4a0e4a4, 0xe498e49c, 0xe494, 0xf23cf238, 0xf244f240, 0xf7e8f7e8, 0xf7e8f7e8, 0x1c90, 0x6230, 0x9ab0, 0xe050, 0x118d0, 0x15e70, 0x1a410
.long 0xe490e494, 0xe488e48c, 0xe480e484, 0xe478e47c, 0xe474, 0xf24cf248, 0xf254f250, 0xf7ecf7ec, 0xf7ecf7ec, 0x1ca0, 0x6240, 0x9ac0, 0xe060, 0x12600, 0x15e80, 0x1a420
.long 0xe470e474, 0xe468e46c, 0xe460e464, 0xe458e45c, 0xe450, 0xf25cf258, 0xf264f260, 0xf7f0f7f0, 0xf7f0f7f0, 0x1cb0, 0x6250, 0x9ad0, 0xe070, 0x12610, 0x15e90, 0x1a430
.long 0xe44ce450, 0xe444e448, 0xe43ce440, 0xe434e438, 0xe430, 0xf270f26c, 0xf278f274, 0xf7f4f7f4, 0xf7f4f7f4, 0x1cc0, 0x6260, 0xa800, 0xe080, 0x12620, 0x15ea0, 0x1a440
.long 0xe42ce430, 0xe424e428, 0xe41ce420, 0xe414e418, 0xe410, 0xf280f27c, 0xf288f284, 0xf7f8f7f8, 0xf7f8f7f8, 0x1cd0, 0x6270, 0xa810, 0xe090, 0x12630, 0x15eb0, 0x1a450
.long 0xe40ce410, 0xe404e408, 0xe3fce400, 0xe3f4e3f8, 0xe3f0, 0xf290f28c, 0xf298f294, 0xf7fcf7fc, 0xf7fcf7fc, 0x2a00, 0x6280, 0xa820, 0xe0a0, 0x12640, 0x15ec0, 0x1a460
.long 0xe3ece3f0, 0xe3e4e3e8, 0xe3dce3e0, 0xe3d4e3d8, 0xe3cc, 0xf2a0f29c, 0xf2a8f2a4, 0xf800f800, 0xf800f800, 0x2a10, 0x6290, 0xa830, 0xe0b0, 0x12650, 0x15ed0, 0x1a470
.long 0xe3c8e3cc, 0xe3c0e3c4, 0xe3b8e3bc, 0xe3b0e3b4, 0xe3ac, 0xf2b0f2ac, 0xf2b8f2b4, 0xf804f804, 0xf804f804, 0x2a20, 0x62a0, 0xa840, 0xe0c0, 0x12660, 0x16c00, 0x1a480
.long 0xe3a8e3ac, 0xe3a0e3a4, 0xe398e39c, 0xe390e394, 0xe38c, 0xf2c0f2bc, 0xf2c8f2c4, 0xf808f808, 0xf808f808, 0x2a30, 0x62b0, 0xa850, 0xe0d0, 0x12670, 0x16c10, 0x1a490
.long 0xe388e38c, 0xe380e384, 0xe378e37c, 0xe370e374, 0xe36c, 0xf2d0f2cc, 0xf2d8f2d4, 0xf80cf80c, 0xf80cf80c, 0x2a40, 0x62c0, 0xa860, 0xee00, 0x12680, 0x16c20, 0x1a4a0
.long 0xe368e36c, 0xe360e364, 0xe358e35c, 0xe350e354, 0xe348, 0xf2e0f2dc, 0xf2e8f2e4, 0xf810f810, 0xf810f810, 0x2a50, 0x62d0, 0xa870, 0xee10, 0x12690, 0x16c30, 0x1a4b0
.long 0xe344e348, 0xe33ce340, 0xe334e338, 0xe32ce330, 0xe328, 0xf378f374, 0xf480f47c, 0xf7d4f7d4, 0xf7d4f7d4, 0x2a60, 0x7000, 0xa880, 0xee20, 0x126a0, 0x16c40, 0x1a4c0
.long 0xe324e328, 0xe31ce320, 0xe314e318, 0xe30ce310, 0xe308, 0xf380f37c, 0xf488f484, 0xf7d8f7d8, 0xf7d8f7d8, 0x2a70, 0x7010, 0xa890, 0xee30, 0x126b0, 0x16c50, 0x1a4d0
.long 0xe304e308, 0xe2fce300, 0xe2f4e2f8, 0xe2ece2f0, 0xe2e8, 0xf388f384, 0xf490f48c, 0xf7dcf7dc, 0xf7dcf7dc, 0x2a80, 0x7020, 0xa8a0, 0xee40, 0x126c0, 0x16c60, 0x1b200
.long 0xe2e4e2e8, 0xe2dce2e0, 0xe2d4e2d8, 0xe2cce2d0, 0xe2c4, 0xf390f38c, 0xf498f494, 0xf7e0f7e0, 0xf7e0f7e0, 0x2a90, 0x7030, 0xa8b0, 0xee50, 0x126d0, 0x16c70, 0x1b210
.long 0xe2c0e2c4, 0xe2b8e2bc, 0xe2b0e2b4, 0xe2a8e2ac, 0xe2a4, 0xf398f394, 0xf4a0f49c, 0xf7e4f7e4, 0xf7e4f7e4, 0x2aa0, 0x7040, 0xa8c0, 0xee60, 0x13400, 0x16c80, 0x1b220
.long 0xe2a0e2a4, 0xe298e29c, 0xe290e294, 0xe288e28c, 0xe284, 0xf3a0f39c, 0xf4a8f4a4, 0xf7e8f7e8, 0xf7e8f7e8, 0x2ab0, 0x7050, 0xa8d0, 0xee70, 0x13410, 0x16c90, 0x1b230
.long 0xe280e284, 0xe278e27c, 0xe270e274, 0xe268e26c, 0xe264, 0xf3a8f3a4, 0xf4b0f4ac, 0xf7ecf7ec, 0xf7ecf7ec, 0x2ac0, 0x7060, 0xb600, 0xee80, 0x13420, 0x16ca0, 0x1b240
.long 0xe260e264, 0xe258e25c, 0xe250e254, 0xe248e24c, 0xe240, 0xf3b0f3ac, 0xf4b8f4b4, 0xf7f0f7f0, 0xf7f0f7f0, 0x2ad0, 0x7070, 0xb610, 0xee90, 0x13430, 0x16cb0, 0x1b250
.long 0xe23ce240, 0xe234e238, 0xe22ce230, 0xe224e228, 0xe220, 0xf3b8f3b4, 0xf4c0f4bc, 0xf7f4f7f4, 0xf7f4f7f4, 0x3800, 0x7080, 0xb620, 0xeea0, 0x13440, 0x16cc0, 0x1b260
.long 0xe21ce220, 0xe214e218, 0xe20ce210, 0xe204e208, 0xe200, 0xf3c0f3bc, 0xf4c8f4c4, 0xf7f8f7f8, 0xf7f8f7f8, 0x3810, 0x7090, 0xb630, 0xeeb0, 0x13450, 0x16cd0, 0x1b270
.long 0xe1fce200, 0xe1f4e1f8, 0xe1ece1f0, 0xe1e4e1e8, 0xe1e0, 0xf3c8f3c4, 0xf4d0f4cc, 0xf7fcf7fc, 0xf7fcf7fc, 0x3820, 0x70a0, 0xb640, 0xeec0, 0x13460, 0x17a00, 0x1b280
.long 0xe1dce1e0, 0xe1d4e1d8, 0xe1cce1d0, 0xe1c4e1c8, 0xe1bc, 0xf3d0f3cc, 0xf4d8f4d4, 0xf800f800, 0xf800f800, 0x3830, 0x70b0, 0xb650, 0xeed0, 0x13470, 0x17a10, 0x1b290
.long 0xe1b8e1bc, 0xe1b0e1b4, 0xe1a8e1ac, 0xe1a0e1a4, 0xe19c, 0xf3d8f3d4, 0xf4e0f4dc, 0xf804f804, 0xf804f804, 0x3840, 0x70c0, 0xb660, 0xfc00, 0x13480, 0x17a20, 0x1b2a0
.long 0xe198e19c, 0xe190e194, 0xe188e18c, 0xe180e184, 0xe17c, 0xf3e0f3dc, 0xf4e8f4e4, 0xf808f808, 0xf808f808, 0x3850, 0x70d0, 0xb670, 0xfc10, 0x13490, 0x17a30, 0x1b2b0
.long 0xe178e17c, 0xe170e174, 0xe168e16c, 0xe160e164, 0xe15c, 0xf3e8f3e4, 0xf4f0f4ec, 0xf80cf80c, 0xf80cf80c, 0x3860, 0x7e00, 0xb680, 0xfc20, 0x134a0, 0x17a40, 0x1b2c0
.long 0xe158e15c, 0xe150e154, 0xe148e14c, 0xe140e144, 0xe140, 0xf3f0f3ec, 0xf4f8f4f4, 0xf810f810, 0xf810f810, 0x3870, 0x7e10, 0xb690, 0xfc30, 0x134b0, 0x17a50, 0x1b2d0
.size sequential_preLN__ssm_conv_s4__mixer_channel_mlp__prompt_kernel_tbl, 16384
.section .rodata,"a"
.p2align 6
.p2align 6
.amdhsa_kernel sequential_preLN__ssm_conv_s4__mixer_channel_mlp__prompt_kernel
  .amdhsa_next_free_vgpr 512
  .amdhsa_next_free_sgpr 102
  .amdhsa_accum_offset 256
  .amdhsa_group_segment_fixed_size 0
  .amdhsa_kernarg_size 136
  .amdhsa_user_sgpr_count 2
  .amdhsa_user_sgpr_kernarg_segment_ptr 1
  .amdhsa_system_sgpr_workgroup_id_x 1
.end_amdhsa_kernel
```
